```python
import torch

def _softmax(x, axis=-1):
    return torch.softmax(x, dim=axis)
def _gelu(x):
    return torch.nn.functional.gelu(x, approximate="tanh")
def _silu(x):
    return torch.nn.functional.silu(x)
def _sigmoid(x):
    return torch.sigmoid(x)
def _layernorm(x, axis=-1, eps=1e-5):
    m = x.mean(dim=axis, keepdim=True)
    v = x.var(dim=axis, keepdim=True, unbiased=False)
    return (x - m) / torch.sqrt(v + eps)
def _scatter_add(tgt, idx, src, axis=0):
    return tgt.clone().index_add_(axis, idx, src)
def _segment_sum(src, seg, n):
    out = torch.zeros((n,) + src.shape[1:], dtype=src.dtype)
    return out.index_add_(0, seg, src)
def _pad(x, pw):
    flat = tuple(v for pair in reversed(pw) for v in pair)
    return torch.nn.functional.pad(x, flat)

kernel_name = 'gather_scatter__edge_featured_mpnn_egc__graph'

def setup_inputs():

    _w = (lambda a: (lambda t: t.to(torch.bfloat16) if t.is_floating_point() else t)(torch.as_tensor(a)))
    N, deg, D, De = 25000, 32, 64, max(0, 1)
    E = N * deg
    return {
        "x": _w((lambda *s: torch.randn(*s, dtype=torch.bfloat16) * 0.2)(N, D)),
        "e_attr": _w((lambda *s: torch.randn(*s, dtype=torch.bfloat16) * 0.2)(E, De)),
        "src": _w((lambda lo, hi, *s: torch.randint(lo, hi, s))(0, N, E).to(torch.int64)),
        "dst": _w((lambda lo, hi, *s: torch.randint(lo, hi, s))(0, N, E).to(torch.int64)),
        "u_w": _w((lambda *s: torch.randn(*s, dtype=torch.bfloat16) * 0.05)(D, D)),
        "v_w": _w((lambda *s: torch.randn(*s, dtype=torch.bfloat16) * 0.05)(D, D)),
        "g_w": _w((lambda *s: torch.randn(*s, dtype=torch.bfloat16) * 0.2)(2 * D + De, D)),
    }

def reference(x, e_attr, src, dst, u_w, v_w, g_w):
    N, D = x.shape
    g_in = torch.concatenate([x[dst], x[src], e_attr], axis=-1)
    eta = _sigmoid(g_in @ g_w)
    hv = x @ v_w
    msg = eta * hv[src]
    agg = _segment_sum(msg, dst, N)
    return _silu(x @ u_w + agg)
```

```asm
; @launch grid=(256,1,1) block=(1024,1,1) lds=154656
.amdgcn_target "amdgcn-amd-amdhsa--gfx950"
.text
.globl gather_scatter__edge_featured_mpnn_egc__graph_kernel
.p2align 8
.type gather_scatter__edge_featured_mpnn_egc__graph_kernel,@function
gather_scatter__edge_featured_mpnn_egc__graph_kernel:
    s_cmp_ge_u32 s2, 256
    s_cbranch_scc1 k_end
    s_load_dwordx2 s[28:29], s[0:1], 24
    s_load_dwordx16 s[4:19], s[0:1], 0
    s_load_dwordx2 s[20:21], s[0:1], 72
    s_load_dwordx2 s[44:45], s[0:1], 64
    s_memrealtime s[100:101]
    s_getpc_b64 s[96:97]
    s_lshr_b32 s3, s2, 3
    s_min_u32 s3, s3, 19
    s_lshl_b32 s3, s3, 9
    v_subrev_u32 v62, 448, v0
    v_lshl_add_u32 v60, v62, 4, s3
    v_cmpx_gt_u32 vcc, 32, v62
    s_cbranch_execz k_noipf
    global_load_dwordx4 v[108:111], v60, s[96:97]
k_noipf:
    s_mov_b64 exec, -1
    v_lshlrev_b32 v61, 4, v0
    s_mul_i32 s85, s2, 3136
    s_lshl_b32 s86, s85, 2
    s_lshl_b32 s87, s85, 1
    s_add_u32 s97, s86, 6272
    s_mov_b32 s30, 3200000
    s_mov_b32 s31, 0x20000
    v_cmp_gt_u32 vcc, 392, v0
    s_mov_b64 s[52:53], vcc
    s_mov_b64 exec, vcc
    s_waitcnt lgkmcnt(0)
    s_cbranch_execz k_noedge0
    buffer_load_dwordx4 v[16:19], v61, s[28:31], s86 offen nt
    buffer_load_dwordx4 v[20:23], v61, s[28:31], s97 offen nt
k_noedge0:
    s_mov_b64 exec, -1
    s_mov_b32 s3, 0
    v_lshrrev_b32 v60, 6, v0
    s_nop 0
    v_readfirstlane_b32 s23, v60
    v_mov_b32 v11, 0
    v_lshlrev_b32 v67, 2, v0
    s_movk_i32 s96, 292
    v_mov_b32 v69, 96256
    v_mad_u32_u24 v68, v0, s96, v69
    s_cmp_lt_u32 s23, 4
    s_cbranch_scc1 k_init_w
    v_subrev_u32 v69, 580, v0
    v_cmp_gt_u32 vcc, 4, v69
    s_nop 1
    v_cndmask_b32 v68, 0, 1.0, vcc
k_init_w:
    ds_write_b32 v67, v68
    s_bfe_u32 s88, s2, 0x20001
    s_lshl_b32 s88, s88, 5
    s_lshr_b32 s96, s2, 3
    s_add_u32 s88, s88, s96
    s_mul_i32 s22, s88, 196
    s_and_b32 s89, s2, 1
    s_lshl_b32 s90, s22, 7
    s_sub_u32 s91, 3200000, s90
    s_min_u32 s91, s91, 25088
    s_lshl_b32 s92, s89, 6
    v_and_b32 v65, 7, v0
    v_lshlrev_b32 v66, 3, v65
    s_waitcnt lgkmcnt(0)
    s_lshl_b32 s96, s2, 4
    s_add_u32 s96, s96, s23
    s_cmp_eq_u32 s96, 7
    s_cbranch_scc0 k_notag
    s_mov_b32 s46, 128
    s_mov_b32 s47, 0x20000
    s_or_b32 s96, s100, 1
    v_mov_b32 v72, s96
    v_mov_b32 v73, s96
    v_mov_b32 v74, s96
    v_mov_b32 v75, s96
    v_lshlrev_b32 v76, 4, v65
    s_mov_b64 exec, 0xff
    buffer_store_dwordx4 v[72:75], v76, s[44:47], 0 offen sc1
    s_mov_b64 exec, -1
k_notag:
    s_cmp_ge_u32 s23, 8
    s_cbranch_scc1 k_node
    s_mov_b32 s32, s8
    s_mov_b32 s33, s9
    s_mov_b32 s34, 3200000
    s_mov_b32 s35, 0x20000
    s_mov_b32 s36, s6
    s_mov_b32 s37, s7
    s_mov_b32 s38, 1600000
    s_mov_b32 s39, 0x20000
    v_lshlrev_b32 v62, 3, v0
    s_mov_b64 exec, s[52:53]
    s_barrier
    s_cbranch_execz k_noedge
    buffer_load_dwordx4 v[24:27], v61, s[32:35], s86 offen nt
    buffer_load_dwordx4 v[28:31], v61, s[32:35], s97 offen nt
    buffer_load_dwordx2 v[32:33], v62, s[36:39], s87 offen nt
    buffer_load_dwordx2 v[34:35], v62, s[36:39], s87 offen offset:3136 nt
k_noedge:
    s_mov_b64 exec, -1
    s_add_u32 s24, s16, 0x4000
    s_addc_u32 s25, s17, 0
    s_mov_b32 s26, 128
    s_mov_b32 s27, 0x20000
    buffer_load_dwordx2 v[122:123], v66, s[24:27], s92 offen
    s_barrier
    v_lshl_add_u32 v63, v0, 2, s85
    v_cmp_gt_u32 vcc, 800000, v63
    s_and_b64 s[54:55], vcc, s[52:53]
    v_cmp_gt_u32 vcc, 798432, v63
    s_and_b64 s[56:57], vcc, s[52:53]
    v_mov_b32 v70, 1
    s_mov_b32 s86, 10700
    s_mov_b32 s87, -49
    v_and_b32 v73, 63, v0
    v_lshlrev_b32 v73, 3, v73
    s_mov_b64 exec, s[54:55]
    s_waitcnt vmcnt(6)
    v_mul_u32_u24 v72, s86, v16
    v_lshrrev_b32 v72, 21, v72
    v_lshlrev_b32 v36, 2, v72
    ds_add_rtn_u32 v44, v36, v70 offset:2560
    v_mad_i32_i24 v16, v36, s87, v16
    v_mul_u32_u24 v72, s86, v17
    v_lshrrev_b32 v72, 21, v72
    v_lshlrev_b32 v37, 2, v72
    ds_add_rtn_u32 v45, v37, v70 offset:2560
    v_mad_i32_i24 v17, v37, s87, v17
    v_mul_u32_u24 v72, s86, v18
    v_lshrrev_b32 v72, 21, v72
    v_lshlrev_b32 v38, 2, v72
    ds_add_rtn_u32 v46, v38, v70 offset:2560
    v_mad_i32_i24 v18, v38, s87, v18
    v_mul_u32_u24 v72, s86, v19
    v_lshrrev_b32 v72, 21, v72
    v_lshlrev_b32 v39, 2, v72
    ds_add_rtn_u32 v47, v39, v70 offset:2560
    v_mad_i32_i24 v19, v39, s87, v19
    s_mov_b64 exec, s[56:57]
    s_waitcnt vmcnt(5)
    v_mul_u32_u24 v72, s86, v20
    v_lshrrev_b32 v72, 21, v72
    v_lshlrev_b32 v40, 2, v72
    ds_add_rtn_u32 v48, v40, v70 offset:2560
    v_mad_i32_i24 v20, v40, s87, v20
    v_mul_u32_u24 v72, s86, v21
    v_lshrrev_b32 v72, 21, v72
    v_lshlrev_b32 v41, 2, v72
    ds_add_rtn_u32 v49, v41, v70 offset:2560
    v_mad_i32_i24 v21, v41, s87, v21
    v_mul_u32_u24 v72, s86, v22
    v_lshrrev_b32 v72, 21, v72
    v_lshlrev_b32 v42, 2, v72
    ds_add_rtn_u32 v50, v42, v70 offset:2560
    v_mad_i32_i24 v22, v42, s87, v22
    v_mul_u32_u24 v72, s86, v23
    v_lshrrev_b32 v72, 21, v72
    v_lshlrev_b32 v43, 2, v72
    ds_add_rtn_u32 v51, v43, v70 offset:2560
    v_mad_i32_i24 v23, v43, s87, v23
    s_mov_b64 exec, 1
    ds_add_u32 v11, v70 offset:2336
    s_mov_b64 exec, -1
k_s2:
    ds_read_b32 v72, v11 offset:2336
    ds_read_b64 v[52:53], v73 offset:2560
    s_waitcnt lgkmcnt(0)
    v_cmp_gt_u32 vcc, 8, v72
    s_cbranch_vccnz k_s2
    v_add_u32 v54, 3, v52
    v_add_u32 v55, 3, v53
    v_and_b32 v54, -4, v54
    v_and_b32 v55, -4, v55
    v_add_u32 v56, v54, v55
    s_nop 1
    v_add_u32_dpp v57, v56, v56 row_shr:1 row_mask:0xf bank_mask:0xf bound_ctrl:0
    s_nop 1
    v_add_u32_dpp v57, v57, v57 row_shr:2 row_mask:0xf bank_mask:0xf bound_ctrl:0
    s_nop 1
    v_add_u32_dpp v57, v57, v57 row_shr:4 row_mask:0xf bank_mask:0xf bound_ctrl:0
    s_nop 1
    v_add_u32_dpp v57, v57, v57 row_shr:8 row_mask:0xf bank_mask:0xf bound_ctrl:0
    s_nop 1
    v_add_u32_dpp v57, v57, v57 row_bcast:15 row_mask:0xa bank_mask:0xf
    s_nop 1
    v_add_u32_dpp v57, v57, v57 row_bcast:31 row_mask:0xc bank_mask:0xf
    v_sub_u32 v58, v57, v56
    v_add_u32 v59, v58, v54
    ds_write_b64 v73, v[58:59] offset:3072
    s_mov_b64 exec, s[54:55]
    ds_read_b32 v36, v36 offset:3072
    ds_read_b32 v37, v37 offset:3072
    ds_read_b32 v38, v38 offset:3072
    ds_read_b32 v39, v39 offset:3072
    s_mov_b64 exec, s[56:57]
    ds_read_b32 v40, v40 offset:3072
    ds_read_b32 v41, v41 offset:3072
    ds_read_b32 v42, v42 offset:3072
    ds_read_b32 v43, v43 offset:3072
    s_mov_b64 exec, -1
    v_readlane_b32 s86, v57, 63
    v_lshl_or_b32 v55, v53, 16, v59
    v_lshl_or_b32 v53, v52, 16, v58
    s_lshl_b32 s86, s86, 2
    s_add_u32 s86, s86, 3711
    s_and_b32 s86, s86, -128
    s_cmp_eq_u32 s23, 7
    s_cbranch_scc0 k_havetag
    s_load_dword s84, s[44:45], 0
    s_mov_b32 s46, 4
    s_mov_b32 s47, 0x20000
    s_mov_b32 s96, 0
    s_waitcnt lgkmcnt(0)
    v_mov_b32 v72, s84
    s_cmp_lg_u32 s84, 0
    s_cbranch_scc1 k_tagok
k_tag:
    buffer_load_dword v72, off, s[44:47], 0 sc1
    s_add_u32 s96, s96, 1
    s_cmp_ge_u32 s96, 400000
    s_cselect_b32 s97, 1, 0
    s_waitcnt vmcnt(0)
    v_or_b32 v72, s97, v72
    v_cmp_eq_u32 vcc, 0, v72
    s_cbranch_vccnz k_tag
k_tagok:
    ds_write_b32 v11, v72 offset:2356
    s_branch k_placed
k_havetag:
    s_mov_b32 s97, 0xffff0000
    s_mov_b64 exec, s[54:55]
    s_waitcnt lgkmcnt(7)
    v_add_u32 v36, v36, v44
    ds_write_b8 v36, v16 offset:4096
    v_lshlrev_b32 v44, 2, v36
    s_waitcnt lgkmcnt(7)
    v_add_u32 v37, v37, v45
    ds_write_b8 v37, v17 offset:4096
    v_lshlrev_b32 v45, 2, v37
    s_waitcnt lgkmcnt(7)
    v_add_u32 v38, v38, v46
    ds_write_b8 v38, v18 offset:4096
    v_lshlrev_b32 v46, 2, v38
    s_waitcnt lgkmcnt(7)
    v_add_u32 v39, v39, v47
    ds_write_b8 v39, v19 offset:4096
    v_lshlrev_b32 v47, 2, v39
    s_mov_b64 exec, s[56:57]
    s_waitcnt lgkmcnt(7)
    v_add_u32 v40, v40, v48
    ds_write_b8 v40, v20 offset:4096
    v_lshlrev_b32 v48, 2, v40
    s_waitcnt lgkmcnt(7)
    v_add_u32 v41, v41, v49
    ds_write_b8 v41, v21 offset:4096
    v_lshlrev_b32 v49, 2, v41
    s_waitcnt lgkmcnt(7)
    v_add_u32 v42, v42, v50
    ds_write_b8 v42, v22 offset:4096
    v_lshlrev_b32 v50, 2, v42
    s_waitcnt lgkmcnt(7)
    v_add_u32 v43, v43, v51
    ds_write_b8 v43, v23 offset:4096
    v_lshlrev_b32 v51, 2, v43
    s_mov_b64 exec, s[54:55]
    s_waitcnt vmcnt(2)
    v_lshl_or_b32 v24, v32, 16, v24
    ds_write_b32 v44, v24 offset:7680
    v_and_or_b32 v25, v32, s97, v25
    ds_write_b32 v45, v25 offset:7680
    v_lshl_or_b32 v26, v33, 16, v26
    ds_write_b32 v46, v26 offset:7680
    v_and_or_b32 v27, v33, s97, v27
    ds_write_b32 v47, v27 offset:7680
    s_mov_b64 exec, s[56:57]
    s_waitcnt vmcnt(1)
    v_lshl_or_b32 v28, v34, 16, v28
    ds_write_b32 v48, v28 offset:7680
    v_and_or_b32 v29, v34, s97, v29
    ds_write_b32 v49, v29 offset:7680
    v_lshl_or_b32 v30, v35, 16, v30
    ds_write_b32 v50, v30 offset:7680
    v_and_or_b32 v31, v35, s97, v31
    ds_write_b32 v51, v31 offset:7680
k_placed:
    s_mov_b64 exec, 1
    ds_add_u32 v11, v70 offset:2340
k_s3:
    ds_read_b32 v72, v11 offset:2340
    ds_read_b32 v124, v11 offset:2356
    s_waitcnt lgkmcnt(0)
    v_cmp_gt_u32 vcc, 8, v72
    s_cbranch_vccnz k_s3
    s_mov_b64 exec, -1
    ds_read_b128 v[16:19], v61 offset:4096
    ds_read_b128 v[20:23], v61 offset:12288
    ds_read_b128 v[24:27], v61 offset:20480
    v_add_u32 v74, 0x2000, v61
    v_add_u32 v75, 0x4000, v61
    s_mul_i32 s97, s2, 18432
    v_readfirstlane_b32 s84, v124
    s_mul_i32 s96, s84, 0x9e3779b1
    s_lshr_b32 s96, s96, 28
    s_mul_i32 s96, s96, 0xd00000
    s_add_u32 s20, s20, s96
    s_addc_u32 s21, s21, 0
    s_add_u32 s44, s20, 0x700000
    s_addc_u32 s45, s21, 0
    s_mov_b32 s46, 294912
    s_mov_b32 s47, 0x20000
    s_add_u32 s28, s20, s97
    s_addc_u32 s29, s21, 0
    s_add_u32 s28, s28, 0x800000
    s_addc_u32 s29, s29, 0
    s_mov_b32 s30, s86
    s_mov_b32 s31, 0x20000
    s_waitcnt lgkmcnt(2)
    buffer_store_dwordx4 v[16:19], v61, s[28:31], 0 offen sc1
    s_waitcnt lgkmcnt(1)
    buffer_store_dwordx4 v[20:23], v74, s[28:31], 0 offen sc1
    s_cmp_ge_u32 s23, 2
    s_cbranch_scc1 k_no3rd
    s_waitcnt lgkmcnt(0)
    buffer_store_dwordx4 v[24:27], v75, s[28:31], 0 offen sc1
k_no3rd:
    s_waitcnt vmcnt(2)
    s_mov_b32 s94, 0xbfb8aa3b
    v_lshlrev_b32 v2, 16, v122
    v_and_b32 v3, 0xffff0000, v122
    v_lshlrev_b32 v4, 16, v123
    v_and_b32 v5, 0xffff0000, v123
    v_mul_f32 v2, s94, v2
    v_mul_f32 v3, s94, v3
    v_mul_f32 v4, s94, v4
    v_mul_f32 v5, s94, v5
    v_mov_b32 v54, s84
    v_mov_b32 v52, s84
    v_lshlrev_b32 v73, 1, v73
    s_lshl_b32 s97, s2, 10
    s_waitcnt vmcnt(0)
    s_mov_b64 exec, 1
    ds_add_rtn_u32 v72, v11, v70 offset:2304
    s_mov_b64 exec, -1
    s_waitcnt lgkmcnt(0)
    v_readfirstlane_b32 s96, v72
    s_cmp_eq_u32 s96, 7
    s_cbranch_scc0 k_nohdr
    buffer_store_dwordx4 v[52:55], v73, s[44:47], s97 offen sc1
    s_mov_b64 exec, 1
    ds_add_u32 v11, v70 offset:2304
    s_mov_b64 exec, -1
k_nohdr:
    s_add_u32 s28, s20, 0x800000
    s_addc_u32 s29, s21, 0
    s_mov_b32 s30, 4718592
    s_mov_b32 s31, 0x20000
    v_lshrrev_b32 v74, 3, v0
    v_lshlrev_b32 v75, 10, v74
    s_lshl_b32 s86, s88, 3
    v_add_u32 v75, s86, v75
    s_mov_b32 s97, 18432
    v_lshlrev_b32 v60, 4, v65
    v_add_u32 v1, 22528, v60
    v_mov_b32 v9, 96256
    v_lshl_add_u32 v10, v65, 3, s92
    v_sub_u32 v10, v10, v1
    s_sub_u32 s96, 3200000, s90
    s_min_u32 s96, s96, 25088
    s_add_u32 s48, s18, s90
    s_addc_u32 s49, s19, 0
    s_mov_b32 s50, s96
    s_mov_b32 s51, 0x20000
    v_lshlrev_b32 v56, 2, v65
    v_mad_u32_u24 v58, v74, s97, v56
    v_mad_u32_u24 v60, v65, 12, v58
    v_mov_b32 v62, 1
    s_mul_i32 s96, s89, 3276800
    s_add_u32 s24, s20, s96
    s_addc_u32 s25, s21, 0
    s_or_b32 s25, s25, 0x800000
    s_mov_b32 s26, 25000
    s_mov_b32 s27, 0x20000
    s_bitcmp1_b32 s23, 1
    s_mov_b32 s87, 0x18091606
    s_cmov_b32 s87, 0x170b1308
    s_mov_b32 s88, 0x120e1007
    s_cmov_b32 s88, 0x150f0d0c
    s_mov_b32 s89, 0xff00ff02
    s_cmov_b32 s89, 0x1411ff01
    s_mov_b32 s90, 0xff04ff03
    s_cmov_b32 s90, 0xff0aff05
    s_bitcmp1_b32 s23, 2
    s_cselect_b32 s87, s88, s87
    s_cselect_b32 s89, s90, s89
    s_bitcmp1_b32 s23, 3
    s_cselect_b32 s87, s89, s87
    s_and_b32 s88, s23, 1
    s_lshl_b32 s88, s88, 4
    s_lshr_b32 s87, s87, s88
    s_bfe_u32 s95, s87, 0x80008
    s_and_b32 s87, s87, 0xff
    v_bfe_u32 v124, v0, 3, 3
    v_lshlrev_b32 v124, 2, v124
    s_lshl_b32 s87, s87, 5
    v_add_u32 v125, s87, v124
    s_min_u32 s87, s95, 24
    s_lshl_b32 s87, s87, 5
    v_add_u32 v126, s87, v124
    v_subrev_u32 v127, 22528, v1
    v_mov_b32 v49, v127
    v_mov_b32 v64, 0
    v_mov_b32 v51, v127
    v_mov_b32 v65, 0
    v_mov_b32 v53, v127
    v_mov_b32 v66, 0
    v_mov_b32 v55, v127
    v_mov_b32 v67, 0
    v_mov_b32 v57, v127
    v_mov_b32 v68, 0
    v_mov_b32 v59, v127
    v_mov_b32 v69, 0
    v_mov_b32 v61, v127
    v_mov_b32 v70, 0
    v_mov_b32 v63, v127
    v_mov_b32 v71, 0
    v_mov_b32 v6, 0
    v_mov_b32 v7, 0
    v_mov_b32 v14, 0
    v_and_b32 v106, 3, v0
    v_lshlrev_b32 v106, 4, v106
    s_mov_b64 s[96:97], 0x3c00
    s_mov_b64 s[100:101], 0x3f80
    v_lshlrev_b64 v[120:121], v106, s[96:97]
    v_lshlrev_b64 v[122:123], v106, s[100:101]
    s_mov_b32 s86, 65536
    s_mov_b32 s87, 131072
    s_mov_b32 s91, 196608
    s_mov_b64 exec, 1
    ds_add_u32 v11, v62 offset:2348
k_s4:
    ds_read_b32 v72, v11 offset:2348
    s_waitcnt lgkmcnt(0)
    v_cmp_gt_u32 vcc, 15, v72
    s_cbranch_vccnz k_s4
    s_mov_b64 exec, -1
    v_mov_b32 v62, 4
    s_mov_b32 s96, 0
    s_mov_b64 s[68:69], -1
    s_mov_b64 s[70:71], -1
    s_mov_b64 s[72:73], -1
    s_mov_b64 s[74:75], -1
k_pollE:
    s_mov_b64 exec, s[68:69]
    buffer_load_dwordx2 v[76:77], v75, s[44:47], 0 offen sc1
    s_mov_b64 exec, s[70:71]
    buffer_load_dwordx2 v[78:79], v75, s[44:47], s86 offen sc1
    s_mov_b64 exec, s[72:73]
    buffer_load_dwordx2 v[80:81], v75, s[44:47], s87 offen sc1
    s_mov_b64 exec, s[74:75]
    buffer_load_dwordx2 v[82:83], v75, s[44:47], s91 offen sc1
    s_mov_b64 exec, -1
k_pollE_chk:
    s_waitcnt vmcnt(0)
    v_cmp_ne_u32 s[68:69], s84, v76
    v_cmp_ne_u32 s[70:71], s84, v78
    v_cmp_ne_u32 s[72:73], s84, v80
    v_cmp_ne_u32 s[74:75], s84, v82
    s_or_b64 vcc, s[68:69], s[70:71]
    s_or_b64 vcc, vcc, s[72:73]
    s_or_b64 vcc, vcc, s[74:75]
    s_cbranch_scc0 k_pollE_ok
    s_add_u32 s96, s96, 1
    s_cmp_lt_u32 s96, 400000
    s_cbranch_scc1 k_pollE
k_pollE_ok:
    s_mov_b32 s86, 1179648
    s_mov_b32 s87, 2359296
    s_mov_b32 s91, 3538944
    v_add_u32_sdwa v76, v58, v77 dst_sel:DWORD dst_unused:UNUSED_PAD src0_sel:DWORD src1_sel:WORD_0
    v_sub_u32_sdwa v84, v77, v56 dst_sel:DWORD dst_unused:UNUSED_PAD src0_sel:WORD_1 src1_sel:DWORD
    v_mad_u32_u16 v48, v77, 4, v60
    v_cmpx_lt_i32 s[52:53], 0, v84
    buffer_load_dword v113, v76, s[28:31], 0 offen sc1
    v_cmpx_lt_i32 vcc, 32, v84
    buffer_load_dword v117, v76, s[28:31], 0 offen offset:32 sc1
    s_mov_b64 exec, -1
    v_add_u32_sdwa v78, v58, v79 dst_sel:DWORD dst_unused:UNUSED_PAD src0_sel:DWORD src1_sel:WORD_0
    v_sub_u32_sdwa v85, v79, v56 dst_sel:DWORD dst_unused:UNUSED_PAD src0_sel:WORD_1 src1_sel:DWORD
    v_mad_u32_u16 v50, v79, 4, v60
    v_cmpx_lt_i32 s[60:61], 0, v85
    buffer_load_dword v114, v78, s[28:31], s86 offen sc1
    v_cmpx_lt_i32 vcc, 32, v85
    buffer_load_dword v118, v78, s[28:31], s86 offen offset:32 sc1
    s_mov_b64 exec, -1
    v_add_u32_sdwa v80, v58, v81 dst_sel:DWORD dst_unused:UNUSED_PAD src0_sel:DWORD src1_sel:WORD_0
    v_sub_u32_sdwa v86, v81, v56 dst_sel:DWORD dst_unused:UNUSED_PAD src0_sel:WORD_1 src1_sel:DWORD
    v_mad_u32_u16 v52, v81, 4, v60
    v_cmpx_lt_i32 s[68:69], 0, v86
    buffer_load_dword v115, v80, s[28:31], s87 offen sc1
    v_cmpx_lt_i32 vcc, 32, v86
    buffer_load_dword v119, v80, s[28:31], s87 offen offset:32 sc1
    s_mov_b64 exec, -1
    v_add_u32_sdwa v82, v58, v83 dst_sel:DWORD dst_unused:UNUSED_PAD src0_sel:DWORD src1_sel:WORD_0
    v_sub_u32_sdwa v87, v83, v56 dst_sel:DWORD dst_unused:UNUSED_PAD src0_sel:WORD_1 src1_sel:DWORD
    v_mad_u32_u16 v54, v83, 4, v60
    v_cmpx_lt_i32 s[76:77], 0, v87
    buffer_load_dword v116, v82, s[28:31], s91 offen sc1
    v_cmpx_lt_i32 vcc, 32, v87
    buffer_load_dword v104, v82, s[28:31], s91 offen offset:32 sc1
    s_mov_b64 exec, -1
    s_mov_b64 exec, s[52:53]
    buffer_load_dwordx4 v[16:19], v48, s[28:31], 0 offen offset:3584 sc1
    v_cmpx_lt_i32 vcc, 32, v84
    buffer_load_dwordx4 v[32:35], v48, s[28:31], 0 offen offset:3712 sc1
    s_mov_b64 exec, s[60:61]
    buffer_load_dwordx4 v[20:23], v50, s[28:31], s86 offen offset:3584 sc1
    v_cmpx_lt_i32 vcc, 32, v85
    buffer_load_dwordx4 v[36:39], v50, s[28:31], s86 offen offset:3712 sc1
    s_mov_b64 exec, s[68:69]
    buffer_load_dwordx4 v[24:27], v52, s[28:31], s87 offen offset:3584 sc1
    v_cmpx_lt_i32 vcc, 32, v86
    buffer_load_dwordx4 v[40:43], v52, s[28:31], s87 offen offset:3712 sc1
    s_mov_b64 exec, s[76:77]
    buffer_load_dwordx4 v[28:31], v54, s[28:31], s91 offen offset:3584 sc1
    v_cmpx_lt_i32 vcc, 32, v87
    buffer_load_dwordx4 v[44:47], v54, s[28:31], s91 offen offset:3712 sc1
    s_mov_b64 exec, -1
    s_mov_b64 exec, 1
    ds_add_u32 v11, v62 offset:2352
    s_mov_b64 exec, -1
    v_max3_i32 v72, v84, v85, v86
    v_max_i32 v72, v72, v87
    v_cmpx_lt_i32 vcc, 64, v72
    ds_write_b32 v11, v62 offset:2312
    s_waitcnt vmcnt(14)
    s_mov_b64 exec, s[52:53]
    v_lshlrev_b32_sdwa v73, 2, v113 dst_sel:DWORD dst_unused:UNUSED_PAD src0_sel:DWORD src1_sel:BYTE_0
    ds_add_rtn_u32 v88, v73, v62 offset:0
    v_cmpx_lt_i32 s[54:55], 1, v84
    v_lshlrev_b32_sdwa v73, 2, v113 dst_sel:DWORD dst_unused:UNUSED_PAD src0_sel:DWORD src1_sel:BYTE_1
    ds_add_rtn_u32 v89, v73, v62 offset:0
    v_cmpx_lt_i32 s[56:57], 2, v84
    v_lshlrev_b32_sdwa v73, 2, v113 dst_sel:DWORD dst_unused:UNUSED_PAD src0_sel:DWORD src1_sel:BYTE_2
    ds_add_rtn_u32 v90, v73, v62 offset:0
    v_cmpx_lt_i32 s[58:59], 3, v84
    v_lshlrev_b32_sdwa v73, 2, v113 dst_sel:DWORD dst_unused:UNUSED_PAD src0_sel:DWORD src1_sel:BYTE_3
    ds_add_rtn_u32 v91, v73, v62 offset:0
    v_cmpx_lt_i32 vcc, 32, v84
    s_cbranch_execz k_exa0
    v_lshlrev_b32_sdwa v73, 2, v117 dst_sel:DWORD dst_unused:UNUSED_PAD src0_sel:DWORD src1_sel:BYTE_0
    ds_add_rtn_u32 v74, v73, v62 offset:0
    v_cmpx_lt_i32 vcc, 33, v84
    v_lshlrev_b32_sdwa v73, 2, v117 dst_sel:DWORD dst_unused:UNUSED_PAD src0_sel:DWORD src1_sel:BYTE_1
    ds_add_rtn_u32 v75, v73, v62 offset:0
    v_cmpx_lt_i32 vcc, 34, v84
    v_lshlrev_b32_sdwa v73, 2, v117 dst_sel:DWORD dst_unused:UNUSED_PAD src0_sel:DWORD src1_sel:BYTE_2
    ds_add_rtn_u32 v76, v73, v62 offset:0
    v_cmpx_lt_i32 vcc, 35, v84
    v_lshlrev_b32_sdwa v73, 2, v117 dst_sel:DWORD dst_unused:UNUSED_PAD src0_sel:DWORD src1_sel:BYTE_3
    ds_add_rtn_u32 v77, v73, v62 offset:0
k_exa0:
    s_waitcnt vmcnt(12)
    s_mov_b64 exec, s[60:61]
    v_lshlrev_b32_sdwa v73, 2, v114 dst_sel:DWORD dst_unused:UNUSED_PAD src0_sel:DWORD src1_sel:BYTE_0
    ds_add_rtn_u32 v92, v73, v62 offset:0
    v_cmpx_lt_i32 s[62:63], 1, v85
    v_lshlrev_b32_sdwa v73, 2, v114 dst_sel:DWORD dst_unused:UNUSED_PAD src0_sel:DWORD src1_sel:BYTE_1
    ds_add_rtn_u32 v93, v73, v62 offset:0
    v_cmpx_lt_i32 s[64:65], 2, v85
    v_lshlrev_b32_sdwa v73, 2, v114 dst_sel:DWORD dst_unused:UNUSED_PAD src0_sel:DWORD src1_sel:BYTE_2
    ds_add_rtn_u32 v94, v73, v62 offset:0
    v_cmpx_lt_i32 s[66:67], 3, v85
    v_lshlrev_b32_sdwa v73, 2, v114 dst_sel:DWORD dst_unused:UNUSED_PAD src0_sel:DWORD src1_sel:BYTE_3
    ds_add_rtn_u32 v95, v73, v62 offset:0
    v_cmpx_lt_i32 vcc, 32, v85
    s_cbranch_execz k_exa1
    v_lshlrev_b32_sdwa v73, 2, v118 dst_sel:DWORD dst_unused:UNUSED_PAD src0_sel:DWORD src1_sel:BYTE_0
    ds_add_rtn_u32 v78, v73, v62 offset:0
    v_cmpx_lt_i32 vcc, 33, v85
    v_lshlrev_b32_sdwa v73, 2, v118 dst_sel:DWORD dst_unused:UNUSED_PAD src0_sel:DWORD src1_sel:BYTE_1
    ds_add_rtn_u32 v79, v73, v62 offset:0
    v_cmpx_lt_i32 vcc, 34, v85
    v_lshlrev_b32_sdwa v73, 2, v118 dst_sel:DWORD dst_unused:UNUSED_PAD src0_sel:DWORD src1_sel:BYTE_2
    ds_add_rtn_u32 v80, v73, v62 offset:0
    v_cmpx_lt_i32 vcc, 35, v85
    v_lshlrev_b32_sdwa v73, 2, v118 dst_sel:DWORD dst_unused:UNUSED_PAD src0_sel:DWORD src1_sel:BYTE_3
    ds_add_rtn_u32 v81, v73, v62 offset:0
k_exa1:
    s_waitcnt vmcnt(10)
    s_mov_b64 exec, s[68:69]
    v_lshlrev_b32_sdwa v73, 2, v115 dst_sel:DWORD dst_unused:UNUSED_PAD src0_sel:DWORD src1_sel:BYTE_0
    ds_add_rtn_u32 v96, v73, v62 offset:0
    v_cmpx_lt_i32 s[70:71], 1, v86
    v_lshlrev_b32_sdwa v73, 2, v115 dst_sel:DWORD dst_unused:UNUSED_PAD src0_sel:DWORD src1_sel:BYTE_1
    ds_add_rtn_u32 v97, v73, v62 offset:0
    v_cmpx_lt_i32 s[72:73], 2, v86
    v_lshlrev_b32_sdwa v73, 2, v115 dst_sel:DWORD dst_unused:UNUSED_PAD src0_sel:DWORD src1_sel:BYTE_2
    ds_add_rtn_u32 v98, v73, v62 offset:0
    v_cmpx_lt_i32 s[74:75], 3, v86
    v_lshlrev_b32_sdwa v73, 2, v115 dst_sel:DWORD dst_unused:UNUSED_PAD src0_sel:DWORD src1_sel:BYTE_3
    ds_add_rtn_u32 v99, v73, v62 offset:0
    v_cmpx_lt_i32 vcc, 32, v86
    s_cbranch_execz k_exa2
    v_lshlrev_b32_sdwa v73, 2, v119 dst_sel:DWORD dst_unused:UNUSED_PAD src0_sel:DWORD src1_sel:BYTE_0
    ds_add_rtn_u32 v82, v73, v62 offset:0
    v_cmpx_lt_i32 vcc, 33, v86
    v_lshlrev_b32_sdwa v73, 2, v119 dst_sel:DWORD dst_unused:UNUSED_PAD src0_sel:DWORD src1_sel:BYTE_1
    ds_add_rtn_u32 v83, v73, v62 offset:0
    v_cmpx_lt_i32 vcc, 34, v86
    v_lshlrev_b32_sdwa v73, 2, v119 dst_sel:DWORD dst_unused:UNUSED_PAD src0_sel:DWORD src1_sel:BYTE_2
    ds_add_rtn_u32 v107, v73, v62 offset:0
    v_cmpx_lt_i32 vcc, 35, v86
    v_lshlrev_b32_sdwa v73, 2, v119 dst_sel:DWORD dst_unused:UNUSED_PAD src0_sel:DWORD src1_sel:BYTE_3
    ds_add_rtn_u32 v108, v73, v62 offset:0
k_exa2:
    s_waitcnt vmcnt(8)
    s_mov_b64 exec, s[76:77]
    v_lshlrev_b32_sdwa v73, 2, v116 dst_sel:DWORD dst_unused:UNUSED_PAD src0_sel:DWORD src1_sel:BYTE_0
    ds_add_rtn_u32 v100, v73, v62 offset:0
    v_cmpx_lt_i32 s[78:79], 1, v87
    v_lshlrev_b32_sdwa v73, 2, v116 dst_sel:DWORD dst_unused:UNUSED_PAD src0_sel:DWORD src1_sel:BYTE_1
    ds_add_rtn_u32 v101, v73, v62 offset:0
    v_cmpx_lt_i32 s[80:81], 2, v87
    v_lshlrev_b32_sdwa v73, 2, v116 dst_sel:DWORD dst_unused:UNUSED_PAD src0_sel:DWORD src1_sel:BYTE_2
    ds_add_rtn_u32 v102, v73, v62 offset:0
    v_cmpx_lt_i32 s[82:83], 3, v87
    v_lshlrev_b32_sdwa v73, 2, v116 dst_sel:DWORD dst_unused:UNUSED_PAD src0_sel:DWORD src1_sel:BYTE_3
    ds_add_rtn_u32 v103, v73, v62 offset:0
    v_cmpx_lt_i32 vcc, 32, v87
    s_cbranch_execz k_exa3
    v_lshlrev_b32_sdwa v73, 2, v104 dst_sel:DWORD dst_unused:UNUSED_PAD src0_sel:DWORD src1_sel:BYTE_0
    ds_add_rtn_u32 v109, v73, v62 offset:0
    v_cmpx_lt_i32 vcc, 33, v87
    v_lshlrev_b32_sdwa v73, 2, v104 dst_sel:DWORD dst_unused:UNUSED_PAD src0_sel:DWORD src1_sel:BYTE_1
    ds_add_rtn_u32 v110, v73, v62 offset:0
    v_cmpx_lt_i32 vcc, 34, v87
    v_lshlrev_b32_sdwa v73, 2, v104 dst_sel:DWORD dst_unused:UNUSED_PAD src0_sel:DWORD src1_sel:BYTE_2
    ds_add_rtn_u32 v111, v73, v62 offset:0
    v_cmpx_lt_i32 vcc, 35, v87
    v_lshlrev_b32_sdwa v73, 2, v104 dst_sel:DWORD dst_unused:UNUSED_PAD src0_sel:DWORD src1_sel:BYTE_3
    ds_add_rtn_u32 v112, v73, v62 offset:0
k_exa3:
    s_mov_b64 exec, 1
    ds_add_u32 v11, v62 offset:2360
    s_mov_b64 exec, s[52:53]
    s_waitcnt vmcnt(6) lgkmcnt(1)
    ds_write_b32 v88, v16
    s_mov_b64 exec, s[54:55]
    ds_write_b32 v89, v17
    s_mov_b64 exec, s[56:57]
    ds_write_b32 v90, v18
    s_mov_b64 exec, s[58:59]
    ds_write_b32 v91, v19
    v_cmpx_lt_i32 vcc, 32, v84
    s_cbranch_execz k_exp0
    ds_write_b32 v74, v32
    v_cmpx_lt_i32 vcc, 33, v84
    ds_write_b32 v75, v33
    v_cmpx_lt_i32 vcc, 34, v84
    ds_write_b32 v76, v34
    v_cmpx_lt_i32 vcc, 35, v84
    ds_write_b32 v77, v35
k_exp0:
    s_mov_b64 exec, s[60:61]
    s_waitcnt vmcnt(4)
    ds_write_b32 v92, v20
    s_mov_b64 exec, s[62:63]
    ds_write_b32 v93, v21
    s_mov_b64 exec, s[64:65]
    ds_write_b32 v94, v22
    s_mov_b64 exec, s[66:67]
    ds_write_b32 v95, v23
    v_cmpx_lt_i32 vcc, 32, v85
    s_cbranch_execz k_exp1
    ds_write_b32 v78, v36
    v_cmpx_lt_i32 vcc, 33, v85
    ds_write_b32 v79, v37
    v_cmpx_lt_i32 vcc, 34, v85
    ds_write_b32 v80, v38
    v_cmpx_lt_i32 vcc, 35, v85
    ds_write_b32 v81, v39
k_exp1:
    s_mov_b64 exec, s[68:69]
    s_waitcnt vmcnt(2)
    ds_write_b32 v96, v24
    s_mov_b64 exec, s[70:71]
    ds_write_b32 v97, v25
    s_mov_b64 exec, s[72:73]
    ds_write_b32 v98, v26
    s_mov_b64 exec, s[74:75]
    ds_write_b32 v99, v27
    v_cmpx_lt_i32 vcc, 32, v86
    s_cbranch_execz k_exp2
    ds_write_b32 v82, v40
    v_cmpx_lt_i32 vcc, 33, v86
    ds_write_b32 v83, v41
    v_cmpx_lt_i32 vcc, 34, v86
    ds_write_b32 v107, v42
    v_cmpx_lt_i32 vcc, 35, v86
    ds_write_b32 v108, v43
k_exp2:
    s_mov_b64 exec, s[76:77]
    s_waitcnt vmcnt(0)
    ds_write_b32 v100, v28
    s_mov_b64 exec, s[78:79]
    ds_write_b32 v101, v29
    s_mov_b64 exec, s[80:81]
    ds_write_b32 v102, v30
    s_mov_b64 exec, s[82:83]
    ds_write_b32 v103, v31
    v_cmpx_lt_i32 vcc, 32, v87
    s_cbranch_execz k_exp3
    ds_write_b32 v109, v44
    v_cmpx_lt_i32 vcc, 33, v87
    ds_write_b32 v110, v45
    v_cmpx_lt_i32 vcc, 34, v87
    ds_write_b32 v111, v46
    v_cmpx_lt_i32 vcc, 35, v87
    ds_write_b32 v112, v47
k_exp3:
k_ext3:
    s_mov_b64 exec, -1
    s_branch k_bar6
k_node:
    s_barrier
    s_add_u32 s40, s4, s90
    s_addc_u32 s41, s5, 0
    s_mov_b32 s42, s91
    s_mov_b32 s43, 0x20000
    v_and_b32 v119, 63, v0
    v_lshlrev_b32 v119, 4, v119
    s_sub_u32 s86, s23, 9
    s_lshl_b32 s86, s86, 12
    v_add_u32 v121, s86, v119
    s_cmp_lt_u32 s23, 12
    s_cselect_b32 s48, s16, s14
    s_cselect_b32 s49, s17, s15
    s_cselect_b32 s36, s16, s12
    s_cselect_b32 s37, s17, s13
    s_cselect_b32 s87, 8192, 0
    s_mov_b32 s50, 16384
    s_mov_b32 s51, 0x20000
    s_mov_b32 s38, 8192
    s_mov_b32 s39, 0x20000
    s_and_b32 s93, s23, 3
    s_lshl_b32 s93, s93, 11
    s_add_u32 s93, s93, s92
    s_add_u32 s87, s87, s93
    v_bfe_u32 v63, v0, 2, 4
    v_and_b32 v64, 3, v0
    v_lshlrev_b32 v64, 4, v64
    v_lshl_add_u32 v60, v63, 7, v64
    s_barrier
    buffer_load_dwordx4 v[48:51], v60, s[48:51], s87 offen
    buffer_load_dwordx4 v[16:19], v121, s[40:43], 0 offen offset:0
    buffer_load_dwordx4 v[20:23], v121, s[40:43], 0 offen offset:1024
    buffer_load_dwordx4 v[24:27], v121, s[40:43], 0 offen offset:2048
    buffer_load_dwordx4 v[28:31], v121, s[40:43], 0 offen offset:3072
    s_add_u32 s24, s16, 0x4000
    s_addc_u32 s25, s17, 0
    s_mov_b32 s26, 128
    s_mov_b32 s27, 0x20000
    buffer_load_dwordx2 v[122:123], v66, s[24:27], s92 offen
    v_mov_b32 v56, 0xffff
    v_mov_b32 v57, 0xffff
    v_mov_b32 v58, 0xffff
    v_mov_b32 v59, 0xffff
    v_add_u32 v120, 88064, v61
    ds_write_b128 v120, v[56:59] offset:0
    ds_write_b128 v120, v[56:59] offset:8192
    ds_write_b128 v120, v[56:59] offset:16384
    ds_write_b128 v120, v[56:59] offset:24576
    ds_write_b128 v120, v[56:59] offset:32768
    ds_write_b128 v120, v[56:59] offset:40960
    ds_write_b128 v120, v[56:59] offset:49152
    s_cmp_lt_u32 s23, 14
    s_cbranch_scc1 k_pfdone
    ds_write_b128 v120, v[56:59] offset:50208
k_pfdone:
    s_add_u32 s87, s86, 22528
    s_lshl_b32 s96, s23, 10
    s_add_u32 s96, s96, 71680
    v_add_u32 v64, s96, v119
    v_add_u32 v63, s87, v119
    v_bfe_u32 v118, v0, 4, 2
    v_lshlrev_b32 v118, 4, v118
    v_xor_b32 v63, v118, v63
    v_xor_b32 v62, 64, v63
    v_and_b32 v116, 31, v0
    v_bfe_u32 v117, v0, 5, 1
    v_bfe_u32 v125, v0, 1, 3
    v_xor_b32 v125, v125, v117
    v_lshlrev_b32 v125, 4, v125
    v_lshl_add_u32 v125, v116, 7, v125
    v_add_u32 v125, s87, v125
    v_bfe_u32 v126, v0, 2, 2
    v_lshl_add_u32 v126, v117, 3, v126
    v_lshlrev_b32 v126, 6, v126
    v_bfe_u32 v127, v0, 4, 1
    v_lshl_add_u32 v126, v127, 5, v126
    v_and_b32 v127, 3, v0
    v_lshl_add_u32 v126, v127, 3, v126
    v_add_u32 v126, 79872, v126
    v_lshlrev_b32 v116, 2, v116
    v_lshl_add_u32 v116, v117, 9, v116
    v_add_u32 v116, s87, v116
    v_bfe_u32 v118, v0, 3, 3
    v_lshlrev_b32 v118, 4, v118
    v_xor_b32 v119, v118, v121
    v_add_u32 v119, 22528, v119
    v_xor_b32 v118, v65, v117
    v_lshlrev_b32 v118, 4, v118
    v_and_b32 v120, 31, v0
    v_lshl_add_u32 v118, v120, 7, v118
    v_add_u32 v118, s87, v118
    s_mov_b32 s94, 0xbfb8aa3b
    v_mov_b32 v127, 1
    s_waitcnt vmcnt(5)
    ds_write_b128 v64, v[48:51] offset:8192
    s_cmp_eq_u32 s23, 8
    s_cbranch_scc1 k_nox
    s_waitcnt vmcnt(4)
    ds_write_b128 v63, v[16:19] offset:0
    s_waitcnt vmcnt(3)
    ds_write_b128 v62, v[20:23] offset:1024
    s_waitcnt vmcnt(2)
    ds_write_b128 v63, v[24:27] offset:2048
    s_waitcnt vmcnt(1)
    ds_write_b128 v62, v[28:31] offset:3072
    ds_read_b128 v[32:35], v125
    v_xor_b32 v120, 32, v125
    ds_read_b128 v[36:39], v120
    v_xor_b32 v120, 64, v125
    ds_read_b128 v[40:43], v120
    v_xor_b32 v120, 0x60, v125
    ds_read_b128 v[44:47], v120
k_nox:
    s_mov_b64 exec, 1
    ds_add_u32 v11, v127 offset:2344
k_sn:
    ds_read_b32 v120, v11 offset:2344
    ds_read_b32 v124, v11 offset:2356
    s_waitcnt lgkmcnt(0)
    v_cmp_gt_u32 vcc, 8, v120
    s_cbranch_vccnz k_sn
    v_cmp_eq_u32 vcc, 0, v124
    s_cbranch_vccnz k_sn
    s_mov_b64 exec, -1
    buffer_load_dwordx4 v[52:55], v60, s[36:39], s93 offen
    s_cmp_eq_u32 s23, 8
    s_cbranch_scc0 k_not8
    v_readfirstlane_b32 s84, v124
    s_mul_i32 s96, s84, 0x9e3779b1
    s_lshr_b32 s96, s96, 28
    s_mul_i32 s96, s96, 0xd00000
    s_add_u32 s20, s20, s96
    s_addc_u32 s21, s21, 0
    s_add_u32 s44, s20, 0x700000
    s_addc_u32 s45, s21, 0
    s_mov_b32 s46, 294912
    s_mov_b32 s47, 0x20000
    s_mov_b32 s32, s20
    s_mov_b32 s33, s21
    s_mov_b32 s34, 0
    s_mov_b32 s35, 0x20000
    s_waitcnt vmcnt(0)
    ds_write_b128 v64, v[52:55]
    s_mov_b64 exec, 1
    ds_add_u32 v11, v127 offset:2368
    s_mov_b64 exec, -1
    s_branch k_w8
k_not8:
    ds_read_b64_tr_b16 v[68:69], v126 offset:8192
    ds_read_b64_tr_b16 v[70:71], v126 offset:8448
    ds_read_b64_tr_b16 v[72:73], v126 offset:9216
    ds_read_b64_tr_b16 v[74:75], v126 offset:9472
    ds_read_b64_tr_b16 v[76:77], v126 offset:10240
    ds_read_b64_tr_b16 v[78:79], v126 offset:10496
    ds_read_b64_tr_b16 v[80:81], v126 offset:11264
    ds_read_b64_tr_b16 v[82:83], v126 offset:11520
    ds_read_b64_tr_b16 v[84:85], v126 offset:12288
    ds_read_b64_tr_b16 v[86:87], v126 offset:12544
    ds_read_b64_tr_b16 v[88:89], v126 offset:13312
    ds_read_b64_tr_b16 v[90:91], v126 offset:13568
    ds_read_b64_tr_b16 v[92:93], v126 offset:14336
    ds_read_b64_tr_b16 v[94:95], v126 offset:14592
    ds_read_b64_tr_b16 v[96:97], v126 offset:15360
    ds_read_b64_tr_b16 v[98:99], v126 offset:15616
    v_readfirstlane_b32 s84, v124
    s_mul_i32 s96, s84, 0x9e3779b1
    s_lshr_b32 s96, s96, 28
    s_mul_i32 s96, s96, 0xd00000
    s_add_u32 s20, s20, s96
    s_addc_u32 s21, s21, 0
    s_add_u32 s44, s20, 0x700000
    s_addc_u32 s45, s21, 0
    s_mov_b32 s46, 294912
    s_mov_b32 s47, 0x20000
    s_mul_i32 s97, s89, 3276800
    s_add_u32 s97, s97, s90
    s_add_u32 s32, s20, s97
    s_addc_u32 s33, s21, 0
    s_mov_b32 s34, s91
    s_mov_b32 s35, 0x20000
    s_waitcnt lgkmcnt(8)
    v_mfma_f32_32x32x16_bf16 v[100:115], v[68:71], v[32:35], 0
    v_mfma_f32_32x32x16_bf16 v[100:115], v[72:75], v[36:39], v[100:115]
    v_mfma_f32_32x32x16_bf16 v[100:115], v[76:79], v[40:43], v[100:115]
    v_mfma_f32_32x32x16_bf16 v[100:115], v[80:83], v[44:47], v[100:115]
    s_waitcnt lgkmcnt(0)
    v_mfma_f32_32x32x16_bf16 v[16:31], v[84:87], v[32:35], 0
    v_mfma_f32_32x32x16_bf16 v[16:31], v[88:91], v[36:39], v[16:31]
    v_mfma_f32_32x32x16_bf16 v[16:31], v[92:95], v[40:43], v[16:31]
    v_mfma_f32_32x32x16_bf16 v[16:31], v[96:99], v[44:47], v[16:31]
    s_nop 7
    v_fma_mixlo_f16 v68, v100, s94, 0
    v_fma_mixlo_f16 v69, v102, s94, 0
    v_fma_mixlo_f16 v72, v104, s94, 0
    v_fma_mixlo_f16 v73, v106, s94, 0
    v_fma_mixlo_f16 v76, v108, s94, 0
    v_fma_mixlo_f16 v77, v110, s94, 0
    v_fma_mixlo_f16 v80, v112, s94, 0
    v_fma_mixlo_f16 v81, v114, s94, 0
    v_fma_mixhi_f16 v68, v101, s94, 0
    v_fma_mixhi_f16 v69, v103, s94, 0
    v_fma_mixhi_f16 v72, v105, s94, 0
    v_fma_mixhi_f16 v73, v107, s94, 0
    v_fma_mixhi_f16 v76, v109, s94, 0
    v_fma_mixhi_f16 v77, v111, s94, 0
    v_fma_mixhi_f16 v80, v113, s94, 0
    v_fma_mixhi_f16 v81, v115, s94, 0
    v_cvt_pk_bf16_f32 v70, v16, v17
    v_cvt_pk_bf16_f32 v71, v18, v19
    ds_write_b128 v118, v[68:71]
    v_cvt_pk_bf16_f32 v74, v20, v21
    v_cvt_pk_bf16_f32 v75, v22, v23
    v_xor_b32 v120, 32, v118
    ds_write_b128 v120, v[72:75]
    v_cvt_pk_bf16_f32 v78, v24, v25
    v_cvt_pk_bf16_f32 v79, v26, v27
    v_xor_b32 v120, 64, v118
    ds_write_b128 v120, v[76:79]
    v_cvt_pk_bf16_f32 v82, v28, v29
    v_cvt_pk_bf16_f32 v83, v30, v31
    v_xor_b32 v120, 96, v118
    ds_write_b128 v120, v[80:83]
    ds_read_b128 v[16:19], v119 offset:0
    ds_read_b128 v[20:23], v119 offset:1024
    ds_read_b128 v[24:27], v119 offset:2048
    ds_read_b128 v[28:31], v119 offset:3072
k_hwait:
    ds_read_b32 v120, v11 offset:2304
    s_waitcnt lgkmcnt(0)
    v_cmp_gt_u32 vcc, 9, v120
    s_cbranch_vccnz k_hwait
    buffer_store_dwordx4 v[16:19], v121, s[32:35], 0 offen offset:0 sc1
    buffer_store_dwordx4 v[20:23], v121, s[32:35], 0 offen offset:1024 sc1
    buffer_store_dwordx4 v[24:27], v121, s[32:35], 0 offen offset:2048 sc1
    buffer_store_dwordx4 v[28:31], v121, s[32:35], 0 offen offset:3072 sc1
    v_max_f32 v66, |v100|, |v101|
    v_max3_f32 v66, |v102|, |v103|, v66
    v_max3_f32 v66, |v104|, |v105|, v66
    v_max3_f32 v66, |v106|, |v107|, v66
    v_max3_f32 v66, |v108|, |v109|, v66
    v_max3_f32 v66, |v110|, |v111|, v66
    v_max3_f32 v66, |v112|, |v113|, v66
    v_max3_f32 v66, |v114|, |v115|, v66
    v_cmp_le_f32 vcc, 0x41300000, v66
    s_cbranch_vccnz k_wide
k_wide_done:
    s_waitcnt vmcnt(4)
    ds_write_b128 v64, v[52:55]
    s_mov_b64 exec, 1
    ds_add_u32 v11, v127 offset:2368
k_sn2:
    ds_read_b32 v120, v11 offset:2368
    s_waitcnt lgkmcnt(0)
    v_cmp_gt_u32 vcc, 8, v120
    s_cbranch_vccnz k_sn2
    s_mov_b64 exec, -1
    s_mov_b64 exec, 1
    ds_add_u32 v11, v127 offset:2348
    s_mov_b64 exec, -1
    ds_read_b64_tr_b16 v[68:69], v126 offset:0
    ds_read_b64_tr_b16 v[70:71], v126 offset:256
    ds_read_b64_tr_b16 v[72:73], v126 offset:1024
    ds_read_b64_tr_b16 v[74:75], v126 offset:1280
    ds_read_b64_tr_b16 v[76:77], v126 offset:2048
    ds_read_b64_tr_b16 v[78:79], v126 offset:2304
    ds_read_b64_tr_b16 v[80:81], v126 offset:3072
    ds_read_b64_tr_b16 v[82:83], v126 offset:3328
    ds_read_b64_tr_b16 v[84:85], v126 offset:4096
    ds_read_b64_tr_b16 v[86:87], v126 offset:4352
    ds_read_b64_tr_b16 v[88:89], v126 offset:5120
    ds_read_b64_tr_b16 v[90:91], v126 offset:5376
    ds_read_b64_tr_b16 v[92:93], v126 offset:6144
    ds_read_b64_tr_b16 v[94:95], v126 offset:6400
    ds_read_b64_tr_b16 v[96:97], v126 offset:7168
    ds_read_b64_tr_b16 v[98:99], v126 offset:7424
    s_waitcnt lgkmcnt(8)
    v_mfma_f32_32x32x16_bf16 v[100:115], v[32:35], v[68:71], 0
    v_mfma_f32_32x32x16_bf16 v[100:115], v[36:39], v[72:75], v[100:115]
    v_mfma_f32_32x32x16_bf16 v[100:115], v[40:43], v[76:79], v[100:115]
    v_mfma_f32_32x32x16_bf16 v[100:115], v[44:47], v[80:83], v[100:115]
    s_waitcnt lgkmcnt(0)
    v_mfma_f32_32x32x16_bf16 v[48:63], v[32:35], v[84:87], 0
    v_mfma_f32_32x32x16_bf16 v[48:63], v[36:39], v[88:91], v[48:63]
    v_mfma_f32_32x32x16_bf16 v[48:63], v[40:43], v[92:95], v[48:63]
    v_mfma_f32_32x32x16_bf16 v[48:63], v[44:47], v[96:99], v[48:63]
k_w8:
    s_waitcnt vmcnt(0)
    s_mov_b64 exec, 1
    ds_add_rtn_u32 v120, v11, v127 offset:2308
    s_mov_b64 exec, -1
    ds_read_b32 v67, v11 offset:2376
    s_mov_b32 s94, 0xbfb8aa3b
    v_lshlrev_b32 v2, 16, v122
    v_and_b32 v3, 0xffff0000, v122
    v_lshlrev_b32 v4, 16, v123
    v_and_b32 v5, 0xffff0000, v123
    v_mul_f32 v2, s94, v2
    v_mul_f32 v3, s94, v3
    v_mul_f32 v4, s94, v4
    v_mul_f32 v5, s94, v5
    s_mul_i32 s96, s89, 3276800
    s_add_u32 s24, s20, s96
    s_addc_u32 s25, s21, 0
    s_or_b32 s25, s25, 0x800000
    s_mov_b32 s26, 25000
    s_mov_b32 s27, 0x20000
    s_lshl_b32 s86, s89, 7
    s_add_u32 s86, s86, 262144
    s_waitcnt lgkmcnt(0)
    v_readfirstlane_b32 s96, v120
    s_cmp_eq_u32 s96, 7
    s_cbranch_scc0 k_notflag
    v_xor_b32 v68, s84, v67
    v_xor_b32 v69, s84, v67
    v_xor_b32 v70, s84, v67
    v_xor_b32 v71, s84, v67
    v_lshlrev_b32 v120, 4, v65
    s_lshl_b32 s96, s88, 8
    s_add_u32 s96, s96, s86
    s_mov_b64 exec, 0xff
    buffer_store_dwordx4 v[68:71], v120, s[44:47], s96 offen sc1
    s_mov_b64 exec, -1
k_notflag:
    s_cmp_eq_u32 s23, 8
    s_cbranch_scc1 k_joined
    v_mul_f32 v100, s94, v100
    ds_write_b32 v116, v100 offset:0
    v_mul_f32 v101, s94, v101
    ds_write_b32 v116, v101 offset:128
    v_mul_f32 v102, s94, v102
    ds_write_b32 v116, v102 offset:256
    v_mul_f32 v103, s94, v103
    ds_write_b32 v116, v103 offset:384
    v_mul_f32 v104, s94, v104
    ds_write_b32 v116, v104 offset:1024
    v_mul_f32 v105, s94, v105
    ds_write_b32 v116, v105 offset:1152
    v_mul_f32 v106, s94, v106
    ds_write_b32 v116, v106 offset:1280
    v_mul_f32 v107, s94, v107
    ds_write_b32 v116, v107 offset:1408
    v_mul_f32 v108, s94, v108
    ds_write_b32 v116, v108 offset:2048
    v_mul_f32 v109, s94, v109
    ds_write_b32 v116, v109 offset:2176
    v_mul_f32 v110, s94, v110
    ds_write_b32 v116, v110 offset:2304
    v_mul_f32 v111, s94, v111
    ds_write_b32 v116, v111 offset:2432
    v_mul_f32 v112, s94, v112
    ds_write_b32 v116, v112 offset:3072
    v_mul_f32 v113, s94, v113
    ds_write_b32 v116, v113 offset:3200
    v_mul_f32 v114, s94, v114
    ds_write_b32 v116, v114 offset:3328
    v_mul_f32 v115, s94, v115
    ds_write_b32 v116, v115 offset:3456
    ds_write_b32 v116, v48 offset:28672
    ds_write_b32 v116, v49 offset:28800
    ds_write_b32 v116, v50 offset:28928
    ds_write_b32 v116, v51 offset:29056
    ds_write_b32 v116, v52 offset:29696
    ds_write_b32 v116, v53 offset:29824
    ds_write_b32 v116, v54 offset:29952
    ds_write_b32 v116, v55 offset:30080
    ds_write_b32 v116, v56 offset:30720
    ds_write_b32 v116, v57 offset:30848
    ds_write_b32 v116, v58 offset:30976
    ds_write_b32 v116, v59 offset:31104
    ds_write_b32 v116, v60 offset:31744
    ds_write_b32 v116, v61 offset:31872
    ds_write_b32 v116, v62 offset:32000
    ds_write_b32 v116, v63 offset:32128
k_nopu:
    s_sub_u32 s87, s23, 8
    s_lshr_b32 s97, s2, 3
    s_lshl_b32 s97, s97, 3
    s_add_u32 s97, s97, s87
    s_lshr_b32 s96, s97, 1
    v_mov_b32 v75, s96
    s_mul_i32 s87, s87, 19
    s_sub_u32 s87, s87, 19
    v_and_b32 v74, 63, v0
    s_mov_b64 exec, 0x7ffff
    v_add_u32 v75, s87, v74
    v_min_u32 v75, 127, v75
    s_mov_b64 exec, -1
    v_lshlrev_b32 v75, 8, v75
    s_mul_i32 s97, s97, 98
    v_lshrrev_b32 v78, 3, v74
    v_add_u32 v78, s97, v78
    v_lshlrev_b32 v79, 4, v65
k_ws5:
    ds_read_b32 v120, v11 offset:2352
    s_waitcnt lgkmcnt(0)
    v_cmp_gt_u32 vcc, 32, v120
    s_cbranch_vccnz k_ws5
    s_mov_b32 s96, 0
    s_mov_b64 s[68:69], -1
k_pollT:
    s_mov_b64 exec, s[68:69]
    buffer_load_dword v76, v75, s[44:47], s86 offen sc1
    s_mov_b64 exec, -1
k_pollT_chk:
    s_waitcnt vmcnt(0)
    v_or_b32 v77, 1, v76
    v_cmp_ne_u32 s[68:69], s84, v77
    s_or_b64 vcc, s[68:69], s[68:69]
    s_cbranch_scc0 k_pollT_ok
    s_add_u32 s96, s96, 1
    s_cmp_lt_u32 s96, 400000
    s_cbranch_scc1 k_pollT
k_pollT_ok:
    v_cmpx_ne_u32 vcc, v76, v77
    ds_write_b32 v11, v127 offset:2316
    s_mov_b64 exec, -1
    buffer_load_dwordx4 v[108:111], v[78:79], s[24:27], 0 idxen offen sc1
    v_add_u32 v78, 8, v78
    buffer_load_dwordx4 v[108:111], v[78:79], s[24:27], 0 idxen offen sc1
    v_add_u32 v78, 8, v78
    buffer_load_dwordx4 v[108:111], v[78:79], s[24:27], 0 idxen offen sc1
    v_add_u32 v78, 8, v78
    s_mov_b64 exec, -1
k_joined:
    v_lshlrev_b32 v60, 4, v65
    v_add_u32 v1, 22528, v60
    v_mov_b32 v9, 96256
    v_lshl_add_u32 v10, v65, 3, s92
    v_sub_u32 v10, v10, v1
    s_sub_u32 s96, 3200000, s90
    s_min_u32 s96, s96, 25088
    s_add_u32 s48, s18, s90
    s_addc_u32 s49, s19, 0
    s_mov_b32 s50, s96
    s_mov_b32 s51, 0x20000
k_presort:
    s_bitcmp1_b32 s23, 1
    s_mov_b32 s87, 0x18091606
    s_cmov_b32 s87, 0x170b1308
    s_mov_b32 s88, 0x120e1007
    s_cmov_b32 s88, 0x150f0d0c
    s_mov_b32 s89, 0xff00ff02
    s_cmov_b32 s89, 0x1411ff01
    s_mov_b32 s90, 0xff04ff03
    s_cmov_b32 s90, 0xff0aff05
    s_bitcmp1_b32 s23, 2
    s_cselect_b32 s87, s88, s87
    s_cselect_b32 s89, s90, s89
    s_bitcmp1_b32 s23, 3
    s_cselect_b32 s87, s89, s87
    s_and_b32 s88, s23, 1
    s_lshl_b32 s88, s88, 4
    s_lshr_b32 s87, s87, s88
    s_bfe_u32 s95, s87, 0x80008
    s_and_b32 s87, s87, 0xff
    v_bfe_u32 v124, v0, 3, 3
    v_lshlrev_b32 v124, 2, v124
    s_lshl_b32 s87, s87, 5
    v_add_u32 v125, s87, v124
    s_min_u32 s87, s95, 24
    s_lshl_b32 s87, s87, 5
    v_add_u32 v126, s87, v124
    v_subrev_u32 v127, 22528, v1
    v_mov_b32 v49, v127
    v_mov_b32 v64, 0
    v_mov_b32 v51, v127
    v_mov_b32 v65, 0
    v_mov_b32 v53, v127
    v_mov_b32 v66, 0
    v_mov_b32 v55, v127
    v_mov_b32 v67, 0
    v_mov_b32 v57, v127
    v_mov_b32 v68, 0
    v_mov_b32 v59, v127
    v_mov_b32 v69, 0
    v_mov_b32 v61, v127
    v_mov_b32 v70, 0
    v_mov_b32 v63, v127
    v_mov_b32 v71, 0
    v_mov_b32 v6, 0
    v_mov_b32 v7, 0
    v_mov_b32 v14, 0
    v_and_b32 v106, 3, v0
    v_lshlrev_b32 v106, 4, v106
    s_mov_b64 s[96:97], 0x3c00
    s_mov_b64 s[100:101], 0x3f80
    v_lshlrev_b64 v[120:121], v106, s[96:97]
    v_lshlrev_b64 v[122:123], v106, s[100:101]
    s_cmp_eq_u32 s23, 8
    s_cbranch_scc0 k_bar6
    v_and_b32 v39, 63, v0
    s_setprio 3
k_ws6:
    ds_read_b32 v38, v11 offset:2360
    s_waitcnt lgkmcnt(0)
    v_cmp_gt_u32 vcc, 32, v38
    s_cbranch_vccnz k_ws6
    v_lshlrev_b32 v32, 4, v39
    ds_read_b128 v[16:19], v32 offset:0
    s_movk_i32 s96, 1168
    v_mov_b32 v33, 96256
    v_mad_u32_u24 v33, v39, s96, v33
    v_mov_b32 v34, 1
    v_lshlrev_b32 v35, 2, v39
    v_cmp_gt_u32 s[100:101], 50, v39
    s_movk_i32 s97, 72
    s_mov_b64 exec, s[100:101]
    s_waitcnt lgkmcnt(0)
    v_sub_u32 v16, v16, v33
    v_add_u32 v33, 292, v33
    v_lshrrev_b32 v16, 2, v16
    v_sub_u32 v17, v17, v33
    v_add_u32 v33, 292, v33
    v_lshrrev_b32 v17, 2, v17
    v_sub_u32 v18, v18, v33
    v_add_u32 v33, 292, v33
    v_lshrrev_b32 v18, 2, v18
    v_sub_u32 v19, v19, v33
    v_lshrrev_b32 v19, 2, v19
    v_max3_u32 v36, v16, v17, v18
    v_max_u32 v36, v36, v19
    v_med3_u32 v16, v16, 9, s97
    v_lshlrev_b32 v20, 2, v16
    v_sub_u32 v20, 288, v20
    ds_add_rtn_u32 v24, v20, v34 offset:1024
    v_med3_u32 v17, v17, 9, s97
    v_lshlrev_b32 v21, 2, v17
    v_sub_u32 v21, 288, v21
    ds_add_rtn_u32 v25, v21, v34 offset:1024
    v_med3_u32 v18, v18, 9, s97
    v_lshlrev_b32 v22, 2, v18
    v_sub_u32 v22, 288, v22
    ds_add_rtn_u32 v26, v22, v34 offset:1024
    v_med3_u32 v19, v19, 9, s97
    v_lshlrev_b32 v23, 2, v19
    v_sub_u32 v23, 288, v23
    ds_add_rtn_u32 v27, v23, v34 offset:1024
    v_cmpx_lt_u32 vcc, 72, v36
    ds_write_b32 v11, v34 offset:2312
    s_mov_b64 exec, -1
    ds_read_b32 v37, v35 offset:1024
    v_lshl_or_b32 v16, v16, 16, v35
    v_lshl_or_b32 v17, v17, 16, v35
    v_add_u32 v17, 1, v17
    v_lshl_or_b32 v18, v18, 16, v35
    v_add_u32 v18, 2, v18
    v_lshl_or_b32 v19, v19, 16, v35
    v_add_u32 v19, 3, v19
    s_waitcnt lgkmcnt(0)
    v_add_u32_dpp v38, v37, v37 row_shr:1 row_mask:0xf bank_mask:0xf bound_ctrl:0
    s_nop 1
    v_add_u32_dpp v38, v38, v38 row_shr:2 row_mask:0xf bank_mask:0xf bound_ctrl:0
    s_nop 1
    v_add_u32_dpp v38, v38, v38 row_shr:4 row_mask:0xf bank_mask:0xf bound_ctrl:0
    s_nop 1
    v_add_u32_dpp v38, v38, v38 row_shr:8 row_mask:0xf bank_mask:0xf bound_ctrl:0
    s_nop 1
    v_add_u32_dpp v38, v38, v38 row_bcast:15 row_mask:0xa bank_mask:0xf
    s_nop 1
    v_add_u32_dpp v38, v38, v38 row_bcast:31 row_mask:0xc bank_mask:0xf
    v_sub_u32 v38, v38, v37
    ds_bpermute_b32 v28, v20, v38
    ds_bpermute_b32 v29, v21, v38
    ds_bpermute_b32 v30, v22, v38
    ds_bpermute_b32 v31, v23, v38
    s_mov_b64 exec, s[100:101]
    s_waitcnt lgkmcnt(3)
    v_add_lshl_u32 v28, v28, v24, 2
    ds_write_b32 v28, v16 offset:1280
    s_waitcnt lgkmcnt(3)
    v_add_lshl_u32 v29, v29, v25, 2
    ds_write_b32 v29, v17 offset:1280
    s_waitcnt lgkmcnt(3)
    v_add_lshl_u32 v30, v30, v26, 2
    ds_write_b32 v30, v18 offset:1280
    s_waitcnt lgkmcnt(3)
    v_add_lshl_u32 v31, v31, v27, 2
    ds_write_b32 v31, v19 offset:1280
    s_mov_b64 exec, -1
k_bar6:
    s_setprio 3
    s_movk_i32 s96, 292
    s_movk_i32 s97, 128
    s_waitcnt lgkmcnt(0)
    s_barrier
    ds_read_b32 v100, v125 offset:1280
    ds_read_b32 v101, v126 offset:1280
    ds_read_b64 v[96:97], v11 offset:2312
    s_waitcnt lgkmcnt(2)
    v_mad_u32_u16 v8, v100, s96, v9
    ds_read_u16 v48, v8 offset:0
    ds_read_u16 v50, v8 offset:4
    ds_read_u16 v52, v8 offset:8
    ds_read_u16 v54, v8 offset:12
    ds_read_u16 v56, v8 offset:16
    ds_read_u16 v58, v8 offset:20
    ds_read_u16 v60, v8 offset:24
    ds_read_u16 v62, v8 offset:28
    v_mad_u32_u16 v12, v100, s97, v1
    v_add_u32 v105, v12, v10
    s_waitcnt lgkmcnt(7)
    buffer_load_dwordx4 v[16:19], v[48:49], s[24:27], 0 idxen offen sc1
    s_waitcnt lgkmcnt(6)
    buffer_load_dwordx4 v[20:23], v[50:51], s[24:27], 0 idxen offen sc1
    s_waitcnt lgkmcnt(5)
    buffer_load_dwordx4 v[24:27], v[52:53], s[24:27], 0 idxen offen sc1
    ds_read_b128 v[72:75], v12
    ds_read_u16_d16_hi v64, v8 offset:2
    ds_read_u16_d16_hi v65, v8 offset:6
    ds_read_u16_d16_hi v66, v8 offset:10
    ds_read_u16_d16_hi v67, v8 offset:14
    ds_read_u16_d16_hi v68, v8 offset:18
    ds_read_u16_d16_hi v69, v8 offset:22
    ds_read_u16_d16_hi v70, v8 offset:26
    ds_read_u16_d16_hi v71, v8 offset:30
    ds_read_b128 v[84:87], v12 offset:28672
    ds_read_b128 v[88:91], v11 offset:2320
    v_add_u32 v8, 32, v8
    v_readfirstlane_b32 s96, v96
    v_readfirstlane_b32 s93, v97
    v_mov_b32 v102, 196
    v_readfirstlane_b32 s87, v100
    v_readfirstlane_b32 s88, v101
    s_cmp_lg_u32 s3, 0
    s_cselect_b32 s96, 0, s96
    s_cmp_lg_u32 s96, 0
    s_cbranch_scc1 k_slow
    s_lshr_b32 s87, s87, 16
    s_lshr_b32 s88, s88, 16
    s_cmp_lt_u32 s95, 25
    s_cbranch_scc1 k_two
    s_mov_b32 s88, 0
    v_mov_b32 v101, 196
k_two:
    s_lshl_b32 s88, s88, 8
    s_or_b32 s86, s87, s88
    s_or_b32 s96, s3, s93
    s_cbranch_scc1 k_safe_w
    s_sub_u32 s90, s87, 1
    s_sub_u32 s89, s87, 8
    s_lshr_b32 s87, s86, 8
    s_mov_b32 s88, s86
    s_mov_b32 s91, 1
    s_mov_b32 s92, 0
    s_waitcnt vmcnt(2) lgkmcnt(0)
    v_mfma_f32_4x4x4_16b_f16 v[76:79], v[120:121], v[16:17], v[72:75]
    v_mfma_f32_4x4x4_16b_bf16 v[112:115], v[122:123], v[18:19], 0
    s_nop 3
    v_pk_fma_f32 v[76:77], v[64:65], v[2:3], v[76:77] op_sel:[0,0,0] op_sel_hi:[0,1,1]
    v_pk_fma_f32 v[78:79], v[64:65], v[4:5], v[78:79] op_sel:[0,0,0] op_sel_hi:[0,1,1]
    s_branch kf_loop
.p2align 6
kf_loop:
    s_waitcnt vmcnt(1)
    v_mfma_f32_4x4x4_16b_f16 v[80:83], v[120:121], v[20:21], v[72:75]
    v_exp_f32 v76, v76
    v_mfma_f32_4x4x4_16b_bf16 v[116:119], v[122:123], v[22:23], 0
    v_exp_f32 v77, v77
    s_waitcnt lgkmcnt(9)
    buffer_load_dwordx4 v[28:31], v[54:55], s[24:27], 0 idxen offen sc1
    v_exp_f32 v78, v78
    s_sub_u32 s89, s89, 1
    s_cbranch_scc1 kf_rs0
kf_rb0:
    ds_read_u16 v48, v8 offset:0
    ds_read_u16_d16_hi v64, v8 offset:2
    v_exp_f32 v79, v79
    v_pk_fma_f32 v[92:93], v[112:113], v[88:89], v[84:85]
    v_pk_fma_f32 v[94:95], v[114:115], v[90:91], v[86:87]
    v_pk_fma_f32 v[88:89], v[88:89], v[76:77], v[88:89]
    v_pk_fma_f32 v[90:91], v[90:91], v[78:79], v[90:91]
    v_pk_fma_f32 v[84:85], v[84:85], v[76:77], v[92:93]
    v_pk_fma_f32 v[86:87], v[86:87], v[78:79], v[94:95]
    s_sub_u32 s90, s90, 1
    s_cbranch_scc1 kf_fs0
kf_fb0:
    v_pk_fma_f32 v[80:81], v[64:65], v[2:3], v[80:81] op_sel:[1,0,0] op_sel_hi:[1,1,1]
    v_pk_fma_f32 v[82:83], v[64:65], v[4:5], v[82:83] op_sel:[1,0,0] op_sel_hi:[1,1,1]
    s_waitcnt vmcnt(1)
    v_mfma_f32_4x4x4_16b_f16 v[76:79], v[120:121], v[24:25], v[72:75]
    v_exp_f32 v80, v80
    v_mfma_f32_4x4x4_16b_bf16 v[112:115], v[122:123], v[26:27], 0
    v_exp_f32 v81, v81
    s_waitcnt lgkmcnt(9)
    buffer_load_dwordx4 v[32:35], v[56:57], s[24:27], 0 idxen offen sc1
    v_exp_f32 v82, v82
    s_sub_u32 s89, s89, 1
    s_cbranch_scc1 kf_rs1
kf_rb1:
    ds_read_u16 v50, v8 offset:4
    ds_read_u16_d16_hi v65, v8 offset:6
    v_exp_f32 v83, v83
    v_pk_fma_f32 v[92:93], v[116:117], v[88:89], v[84:85]
    v_pk_fma_f32 v[94:95], v[118:119], v[90:91], v[86:87]
    v_pk_fma_f32 v[88:89], v[88:89], v[80:81], v[88:89]
    v_pk_fma_f32 v[90:91], v[90:91], v[82:83], v[90:91]
    v_pk_fma_f32 v[84:85], v[84:85], v[80:81], v[92:93]
    v_pk_fma_f32 v[86:87], v[86:87], v[82:83], v[94:95]
    s_sub_u32 s90, s90, 1
    s_cbranch_scc1 kf_fs1
kf_fb1:
    v_pk_fma_f32 v[76:77], v[66:67], v[2:3], v[76:77] op_sel:[0,0,0] op_sel_hi:[0,1,1]
    v_pk_fma_f32 v[78:79], v[66:67], v[4:5], v[78:79] op_sel:[0,0,0] op_sel_hi:[0,1,1]
    s_waitcnt vmcnt(1)
    v_mfma_f32_4x4x4_16b_f16 v[80:83], v[120:121], v[28:29], v[72:75]
    v_exp_f32 v76, v76
    v_mfma_f32_4x4x4_16b_bf16 v[116:119], v[122:123], v[30:31], 0
    v_exp_f32 v77, v77
    s_waitcnt lgkmcnt(9)
    buffer_load_dwordx4 v[36:39], v[58:59], s[24:27], 0 idxen offen sc1
    v_exp_f32 v78, v78
    s_sub_u32 s89, s89, 1
    s_cbranch_scc1 kf_rs2
kf_rb2:
    ds_read_u16 v52, v8 offset:8
    ds_read_u16_d16_hi v66, v8 offset:10
    v_exp_f32 v79, v79
    v_pk_fma_f32 v[92:93], v[112:113], v[88:89], v[84:85]
    v_pk_fma_f32 v[94:95], v[114:115], v[90:91], v[86:87]
    v_pk_fma_f32 v[88:89], v[88:89], v[76:77], v[88:89]
    v_pk_fma_f32 v[90:91], v[90:91], v[78:79], v[90:91]
    v_pk_fma_f32 v[84:85], v[84:85], v[76:77], v[92:93]
    v_pk_fma_f32 v[86:87], v[86:87], v[78:79], v[94:95]
    s_sub_u32 s90, s90, 1
    s_cbranch_scc1 kf_fs2
kf_fb2:
    v_pk_fma_f32 v[80:81], v[66:67], v[2:3], v[80:81] op_sel:[1,0,0] op_sel_hi:[1,1,1]
    v_pk_fma_f32 v[82:83], v[66:67], v[4:5], v[82:83] op_sel:[1,0,0] op_sel_hi:[1,1,1]
    s_waitcnt vmcnt(1)
    v_mfma_f32_4x4x4_16b_f16 v[76:79], v[120:121], v[32:33], v[72:75]
    v_exp_f32 v80, v80
    v_mfma_f32_4x4x4_16b_bf16 v[112:115], v[122:123], v[34:35], 0
    v_exp_f32 v81, v81
    s_waitcnt lgkmcnt(9)
    buffer_load_dwordx4 v[40:43], v[60:61], s[24:27], 0 idxen offen sc1
    v_exp_f32 v82, v82
    s_sub_u32 s89, s89, 1
    s_cbranch_scc1 kf_rs3
kf_rb3:
    ds_read_u16 v54, v8 offset:12
    ds_read_u16_d16_hi v67, v8 offset:14
    v_exp_f32 v83, v83
    v_pk_fma_f32 v[92:93], v[116:117], v[88:89], v[84:85]
    v_pk_fma_f32 v[94:95], v[118:119], v[90:91], v[86:87]
    v_pk_fma_f32 v[88:89], v[88:89], v[80:81], v[88:89]
    v_pk_fma_f32 v[90:91], v[90:91], v[82:83], v[90:91]
    v_pk_fma_f32 v[84:85], v[84:85], v[80:81], v[92:93]
    v_pk_fma_f32 v[86:87], v[86:87], v[82:83], v[94:95]
    s_sub_u32 s90, s90, 1
    s_cbranch_scc1 kf_fs3
kf_fb3:
    v_pk_fma_f32 v[76:77], v[68:69], v[2:3], v[76:77] op_sel:[0,0,0] op_sel_hi:[0,1,1]
    v_pk_fma_f32 v[78:79], v[68:69], v[4:5], v[78:79] op_sel:[0,0,0] op_sel_hi:[0,1,1]
    s_waitcnt vmcnt(1)
    v_mfma_f32_4x4x4_16b_f16 v[80:83], v[120:121], v[36:37], v[72:75]
    v_exp_f32 v76, v76
    v_mfma_f32_4x4x4_16b_bf16 v[116:119], v[122:123], v[38:39], 0
    v_exp_f32 v77, v77
    s_waitcnt lgkmcnt(9)
    buffer_load_dwordx4 v[44:47], v[62:63], s[24:27], 0 idxen offen sc1
    v_exp_f32 v78, v78
    s_sub_u32 s89, s89, 1
    s_cbranch_scc1 kf_rs4
kf_rb4:
    ds_read_u16 v56, v8 offset:16
    ds_read_u16_d16_hi v68, v8 offset:18
    v_exp_f32 v79, v79
    v_pk_fma_f32 v[92:93], v[112:113], v[88:89], v[84:85]
    v_pk_fma_f32 v[94:95], v[114:115], v[90:91], v[86:87]
    v_pk_fma_f32 v[88:89], v[88:89], v[76:77], v[88:89]
    v_pk_fma_f32 v[90:91], v[90:91], v[78:79], v[90:91]
    v_pk_fma_f32 v[84:85], v[84:85], v[76:77], v[92:93]
    v_pk_fma_f32 v[86:87], v[86:87], v[78:79], v[94:95]
    s_sub_u32 s90, s90, 1
    s_cbranch_scc1 kf_fs4
kf_fb4:
    v_pk_fma_f32 v[80:81], v[68:69], v[2:3], v[80:81] op_sel:[1,0,0] op_sel_hi:[1,1,1]
    v_pk_fma_f32 v[82:83], v[68:69], v[4:5], v[82:83] op_sel:[1,0,0] op_sel_hi:[1,1,1]
    s_waitcnt vmcnt(1)
    v_mfma_f32_4x4x4_16b_f16 v[76:79], v[120:121], v[40:41], v[72:75]
    v_exp_f32 v80, v80
    v_mfma_f32_4x4x4_16b_bf16 v[112:115], v[122:123], v[42:43], 0
    v_exp_f32 v81, v81
    s_waitcnt lgkmcnt(9)
    buffer_load_dwordx4 v[16:19], v[48:49], s[24:27], 0 idxen offen sc1
    v_exp_f32 v82, v82
    s_sub_u32 s89, s89, 1
    s_cbranch_scc1 kf_rs5
kf_rb5:
    ds_read_u16 v58, v8 offset:20
    ds_read_u16_d16_hi v69, v8 offset:22
    v_exp_f32 v83, v83
    v_pk_fma_f32 v[92:93], v[116:117], v[88:89], v[84:85]
    v_pk_fma_f32 v[94:95], v[118:119], v[90:91], v[86:87]
    v_pk_fma_f32 v[88:89], v[88:89], v[80:81], v[88:89]
    v_pk_fma_f32 v[90:91], v[90:91], v[82:83], v[90:91]
    v_pk_fma_f32 v[84:85], v[84:85], v[80:81], v[92:93]
    v_pk_fma_f32 v[86:87], v[86:87], v[82:83], v[94:95]
    s_sub_u32 s90, s90, 1
    s_cbranch_scc1 kf_fs5
kf_fb5:
    v_pk_fma_f32 v[76:77], v[70:71], v[2:3], v[76:77] op_sel:[0,0,0] op_sel_hi:[0,1,1]
    v_pk_fma_f32 v[78:79], v[70:71], v[4:5], v[78:79] op_sel:[0,0,0] op_sel_hi:[0,1,1]
    s_waitcnt vmcnt(1)
    v_mfma_f32_4x4x4_16b_f16 v[80:83], v[120:121], v[44:45], v[72:75]
    v_exp_f32 v76, v76
    v_mfma_f32_4x4x4_16b_bf16 v[116:119], v[122:123], v[46:47], 0
    v_exp_f32 v77, v77
    s_waitcnt lgkmcnt(9)
    buffer_load_dwordx4 v[20:23], v[50:51], s[24:27], 0 idxen offen sc1
    v_exp_f32 v78, v78
    s_sub_u32 s89, s89, 1
    s_cbranch_scc1 kf_rs6
kf_rb6:
    ds_read_u16 v60, v8 offset:24
    ds_read_u16_d16_hi v70, v8 offset:26
    v_exp_f32 v79, v79
    v_pk_fma_f32 v[92:93], v[112:113], v[88:89], v[84:85]
    v_pk_fma_f32 v[94:95], v[114:115], v[90:91], v[86:87]
    v_pk_fma_f32 v[88:89], v[88:89], v[76:77], v[88:89]
    v_pk_fma_f32 v[90:91], v[90:91], v[78:79], v[90:91]
    v_pk_fma_f32 v[84:85], v[84:85], v[76:77], v[92:93]
    v_pk_fma_f32 v[86:87], v[86:87], v[78:79], v[94:95]
    s_sub_u32 s90, s90, 1
    s_cbranch_scc1 kf_fs6
kf_fb6:
    v_pk_fma_f32 v[80:81], v[70:71], v[2:3], v[80:81] op_sel:[1,0,0] op_sel_hi:[1,1,1]
    v_pk_fma_f32 v[82:83], v[70:71], v[4:5], v[82:83] op_sel:[1,0,0] op_sel_hi:[1,1,1]
    s_waitcnt vmcnt(1)
    v_mfma_f32_4x4x4_16b_f16 v[76:79], v[120:121], v[16:17], v[72:75]
    v_exp_f32 v80, v80
    v_mfma_f32_4x4x4_16b_bf16 v[112:115], v[122:123], v[18:19], 0
    v_exp_f32 v81, v81
    s_waitcnt lgkmcnt(9)
    buffer_load_dwordx4 v[24:27], v[52:53], s[24:27], 0 idxen offen sc1
    v_exp_f32 v82, v82
    s_sub_u32 s89, s89, 1
    s_cbranch_scc1 kf_rs7
kf_rb7:
    ds_read_u16 v62, v8 offset:28
    ds_read_u16_d16_hi v71, v8 offset:30
    v_exp_f32 v83, v83
    v_pk_fma_f32 v[92:93], v[116:117], v[88:89], v[84:85]
    v_pk_fma_f32 v[94:95], v[118:119], v[90:91], v[86:87]
    v_pk_fma_f32 v[88:89], v[88:89], v[80:81], v[88:89]
    v_pk_fma_f32 v[90:91], v[90:91], v[82:83], v[90:91]
    v_pk_fma_f32 v[84:85], v[84:85], v[80:81], v[92:93]
    v_pk_fma_f32 v[86:87], v[86:87], v[82:83], v[94:95]
    v_add_u32 v8, 32, v8
    s_sub_u32 s90, s90, 1
    s_cbranch_scc1 kf_fs7
kf_fb7:
    v_pk_fma_f32 v[76:77], v[64:65], v[2:3], v[76:77] op_sel:[0,0,0] op_sel_hi:[0,1,1]
    v_pk_fma_f32 v[78:79], v[64:65], v[4:5], v[78:79] op_sel:[0,0,0] op_sel_hi:[0,1,1]
    s_lshr_b32 s96, s88, 8
    s_add_u32 s96, s96, s90
    s_cmp_gt_u32 s96, 32
    s_cbranch_scc1 kf_loop
    s_setprio 2
    s_cmp_gt_u32 s96, 16
    s_cbranch_scc1 kf_loop
    s_setprio 1
    s_cmp_gt_u32 s96, 8
    s_cbranch_scc1 kf_loop
    s_setprio 0
    s_branch kf_loop
kf_rs0:
    s_movk_i32 s97, 0
    s_call_b64 s[100:101], k_rdswitch
    s_branch kf_rb0
kf_rs1:
    s_movk_i32 s97, 4
    s_call_b64 s[100:101], k_rdswitch
    s_branch kf_rb1
kf_rs2:
    s_movk_i32 s97, 8
    s_call_b64 s[100:101], k_rdswitch
    s_branch kf_rb2
kf_rs3:
    s_movk_i32 s97, 12
    s_call_b64 s[100:101], k_rdswitch
    s_branch kf_rb3
kf_rs4:
    s_movk_i32 s97, 16
    s_call_b64 s[100:101], k_rdswitch
    s_branch kf_rb4
kf_rs5:
    s_movk_i32 s97, 20
    s_call_b64 s[100:101], k_rdswitch
    s_branch kf_rb5
kf_rs6:
    s_movk_i32 s97, 24
    s_call_b64 s[100:101], k_rdswitch
    s_branch kf_rb6
kf_rs7:
    s_movk_i32 s97, 28
    s_call_b64 s[100:101], k_rdswitch
    s_branch kf_rb7
kf_fs0:
    s_call_b64 s[100:101], kf_flush
    s_cbranch_scc1 kf_done
    v_mfma_f32_4x4x4_16b_f16 v[80:83], v[120:121], v[20:21], v[72:75]
    s_nop 3
    s_branch kf_fb0
kf_fs1:
    s_call_b64 s[100:101], kf_flush
    s_cbranch_scc1 kf_done
    v_mfma_f32_4x4x4_16b_f16 v[76:79], v[120:121], v[24:25], v[72:75]
    s_nop 3
    s_branch kf_fb1
kf_fs2:
    s_call_b64 s[100:101], kf_flush
    s_cbranch_scc1 kf_done
    v_mfma_f32_4x4x4_16b_f16 v[80:83], v[120:121], v[28:29], v[72:75]
    s_nop 3
    s_branch kf_fb2
kf_fs3:
    s_call_b64 s[100:101], kf_flush
    s_cbranch_scc1 kf_done
    v_mfma_f32_4x4x4_16b_f16 v[76:79], v[120:121], v[32:33], v[72:75]
    s_nop 3
    s_branch kf_fb3
kf_fs4:
    s_call_b64 s[100:101], kf_flush
    s_cbranch_scc1 kf_done
    v_mfma_f32_4x4x4_16b_f16 v[80:83], v[120:121], v[36:37], v[72:75]
    s_nop 3
    s_branch kf_fb4
kf_fs5:
    s_call_b64 s[100:101], kf_flush
    s_cbranch_scc1 kf_done
    v_mfma_f32_4x4x4_16b_f16 v[76:79], v[120:121], v[40:41], v[72:75]
    s_nop 3
    s_branch kf_fb5
kf_fs6:
    s_call_b64 s[100:101], kf_flush
    s_cbranch_scc1 kf_done
    v_mfma_f32_4x4x4_16b_f16 v[80:83], v[120:121], v[44:45], v[72:75]
    s_nop 3
    s_branch kf_fb6
kf_fs7:
    s_call_b64 s[100:101], kf_flush
    s_cbranch_scc1 kf_done
    v_mfma_f32_4x4x4_16b_f16 v[76:79], v[120:121], v[16:17], v[72:75]
    s_nop 3
    s_branch kf_fb7
kf_flush:
    s_add_u32 s92, s92, 1
    s_movk_i32 s96, 128
    s_set_gpr_idx_on s92, gpr_idx(SRC0)
    v_mad_u32_u16 v12, v100, s96, v1
    s_set_gpr_idx_off
    ds_read_b128 v[72:75], v12
    v_rcp_f32 v92, v88
    v_rcp_f32 v93, v89
    v_rcp_f32 v94, v90
    v_rcp_f32 v95, v91
    v_max3_f32 v14, v88, v89, v14
    v_max3_f32 v14, v90, v91, v14
    v_pk_mul_f32 v[92:93], v[84:85], v[92:93]
    v_pk_mul_f32 v[94:95], v[86:87], v[94:95]
    ds_read_b128 v[88:91], v11 offset:2320
    ds_read_b128 v[84:87], v12 offset:28672
    v_pk_mul_f32 v[96:97], v[92:93], s[94:95] op_sel_hi:[1,0]
    v_pk_mul_f32 v[98:99], v[94:95], s[94:95] op_sel_hi:[1,0]
    v_exp_f32 v96, v96
    v_exp_f32 v97, v97
    v_exp_f32 v98, v98
    v_exp_f32 v99, v99
    v_pk_fma_f32 v[6:7], v[92:93], v[94:95], v[6:7]
    v_pk_add_f32 v[96:97], v[96:97], 1.0 op_sel_hi:[1,0]
    v_pk_add_f32 v[98:99], v[98:99], 1.0 op_sel_hi:[1,0]
    v_rcp_f32 v96, v96
    v_rcp_f32 v97, v97
    v_rcp_f32 v98, v98
    v_rcp_f32 v99, v99
    s_nop 0
    v_pk_mul_f32 v[96:97], v[96:97], v[92:93]
    v_pk_mul_f32 v[98:99], v[98:99], v[94:95]
    v_cvt_pk_bf16_f32 v96, v96, v97
    v_cvt_pk_bf16_f32 v97, v98, v99
    buffer_store_dwordx2 v[96:97], v105, s[48:51], 0 offen nt
    v_add_u32 v105, v12, v10
    s_lshr_b32 s88, s88, 8
    s_sub_u32 s90, s88, 1
    s_waitcnt lgkmcnt(0)
    s_setpc_b64 s[100:101]
k_rdswitch:
    s_movk_i32 s96, 292
    s_set_gpr_idx_on s91, gpr_idx(SRC0)
    v_mad_u32_u16 v8, v100, s96, v9
    s_set_gpr_idx_off
    s_add_u32 s91, s91, 1
    s_and_b32 s89, s87, 0xff
    s_lshr_b32 s87, s87, 8
    s_sub_u32 s89, s89, 1
    v_subrev_u32 v8, s97, v8
    s_setpc_b64 s[100:101]
kf_done:
    v_add_f32 v12, |v6|, |v7|
    v_add_f32 v12, v12, v14
    v_mov_b32 v13, 0x7e800000
    v_cmp_nlt_f32 vcc, v12, v13
    s_cbranch_vccnz k_safe_w
    s_endpgm
k_safe_w:
    s_waitcnt vmcnt(0) lgkmcnt(0)
    s_mul_i32 s96, s84, 0x9e3779b1
    s_lshr_b32 s96, s96, 28
    s_mul_i32 s96, s96, 0xd00000
    s_sub_u32 s96, 0xe000000, s96
    s_add_u32 s40, s24, s96
    s_addc_u32 s41, s25, 0
    s_mov_b32 s42, 25000
    s_mov_b32 s43, 0x20000
    s_mov_b32 s87, s86
    s_mov_b32 s88, s86
    s_mov_b32 s89, 0
    s_mov_b32 s91, 0
    s_mov_b32 s92, 0
    s_and_b32 s90, s86, 0xff
    s_sub_u32 s90, s90, 1
    s_sub_u32 s89, s89, 1
    s_cbranch_scc1 ksp_rs0
ksp_rb0:
    ds_read_u16 v48, v8 offset:0
    ds_read_u16_d16_hi v64, v8 offset:2
    s_sub_u32 s89, s89, 1
    s_cbranch_scc1 ksp_rs1
ksp_rb1:
    ds_read_u16 v50, v8 offset:4
    ds_read_u16_d16_hi v65, v8 offset:6
    s_sub_u32 s89, s89, 1
    s_cbranch_scc1 ksp_rs2
ksp_rb2:
    ds_read_u16 v52, v8 offset:8
    ds_read_u16_d16_hi v66, v8 offset:10
    s_sub_u32 s89, s89, 1
    s_cbranch_scc1 ksp_rs3
ksp_rb3:
    ds_read_u16 v54, v8 offset:12
    ds_read_u16_d16_hi v67, v8 offset:14
    s_sub_u32 s89, s89, 1
    s_cbranch_scc1 ksp_rs4
ksp_rb4:
    ds_read_u16 v56, v8 offset:16
    ds_read_u16_d16_hi v68, v8 offset:18
    s_sub_u32 s89, s89, 1
    s_cbranch_scc1 ksp_rs5
ksp_rb5:
    ds_read_u16 v58, v8 offset:20
    ds_read_u16_d16_hi v69, v8 offset:22
    s_sub_u32 s89, s89, 1
    s_cbranch_scc1 ksp_rs6
ksp_rb6:
    ds_read_u16 v60, v8 offset:24
    ds_read_u16_d16_hi v70, v8 offset:26
    s_sub_u32 s89, s89, 1
    s_cbranch_scc1 ksp_rs7
ksp_rb7:
    ds_read_u16 v62, v8 offset:28
    ds_read_u16_d16_hi v71, v8 offset:30
    v_add_u32 v8, 32, v8
    s_movk_i32 s96, 128
    v_mad_u32_u16 v12, v100, s96, v1
    v_add_u32 v105, v12, v10
    s_waitcnt lgkmcnt(15)
    buffer_load_dwordx4 v[16:19], v[48:49], s[24:27], 0 idxen offen sc1
    buffer_load_dwordx4 v[32:35], v[48:49], s[40:43], 0 idxen offen sc1
    s_waitcnt lgkmcnt(13)
    buffer_load_dwordx4 v[20:23], v[50:51], s[24:27], 0 idxen offen sc1
    buffer_load_dwordx4 v[36:39], v[50:51], s[40:43], 0 idxen offen sc1
    s_waitcnt lgkmcnt(11)
    buffer_load_dwordx4 v[24:27], v[52:53], s[24:27], 0 idxen offen sc1
    buffer_load_dwordx4 v[40:43], v[52:53], s[40:43], 0 idxen offen sc1
    ds_read_b128 v[72:75], v12
    ds_read_b128 v[84:87], v12 offset:28672
ks_enter:
    s_waitcnt vmcnt(4) lgkmcnt(0)
    v_mfma_f32_4x4x4_16b_bf16 v[112:115], v[122:123], v[18:19], 0
    v_mfma_f32_4x4x4_16b_f16 v[76:79], v[120:121], v[16:17], 0
    s_mov_b32 s96, 0x41800000
    s_nop 3
    v_cmp_le_f32 vcc, s96, |v76|
    s_nop 1
    v_cndmask_b32 v76, v76, v32, vcc
    v_cmp_le_f32 vcc, s96, |v77|
    s_nop 1
    v_cndmask_b32 v77, v77, v33, vcc
    v_cmp_le_f32 vcc, s96, |v78|
    s_nop 1
    v_cndmask_b32 v78, v78, v34, vcc
    v_cmp_le_f32 vcc, s96, |v79|
    s_nop 1
    v_cndmask_b32 v79, v79, v35, vcc
    v_pk_add_f32 v[76:77], v[76:77], v[72:73]
    v_pk_add_f32 v[78:79], v[78:79], v[74:75]
    v_pk_fma_f32 v[76:77], v[64:65], v[2:3], v[76:77] op_sel:[0,0,0] op_sel_hi:[0,1,1]
    v_pk_fma_f32 v[78:79], v[64:65], v[4:5], v[78:79] op_sel:[0,0,0] op_sel_hi:[0,1,1]
    s_branch ks_loop
ksp_rs0:
    s_movk_i32 s97, 0
    s_call_b64 s[100:101], k_rdswitch
    s_branch ksp_rb0
ksp_rs1:
    s_movk_i32 s97, 4
    s_call_b64 s[100:101], k_rdswitch
    s_branch ksp_rb1
ksp_rs2:
    s_movk_i32 s97, 8
    s_call_b64 s[100:101], k_rdswitch
    s_branch ksp_rb2
ksp_rs3:
    s_movk_i32 s97, 12
    s_call_b64 s[100:101], k_rdswitch
    s_branch ksp_rb3
ksp_rs4:
    s_movk_i32 s97, 16
    s_call_b64 s[100:101], k_rdswitch
    s_branch ksp_rb4
ksp_rs5:
    s_movk_i32 s97, 20
    s_call_b64 s[100:101], k_rdswitch
    s_branch ksp_rb5
ksp_rs6:
    s_movk_i32 s97, 24
    s_call_b64 s[100:101], k_rdswitch
    s_branch ksp_rb6
ksp_rs7:
    s_movk_i32 s97, 28
    s_call_b64 s[100:101], k_rdswitch
    s_branch ksp_rb7
ks_loop:
    s_waitcnt vmcnt(2)
    v_mfma_f32_4x4x4_16b_f16 v[80:83], v[120:121], v[20:21], 0
    s_mov_b32 s96, 0x41800000
    s_nop 3
    v_cmp_le_f32 vcc, s96, |v80|
    s_nop 1
    v_cndmask_b32 v80, v80, v36, vcc
    v_cmp_le_f32 vcc, s96, |v81|
    s_nop 1
    v_cndmask_b32 v81, v81, v37, vcc
    v_cmp_le_f32 vcc, s96, |v82|
    s_nop 1
    v_cndmask_b32 v82, v82, v38, vcc
    v_cmp_le_f32 vcc, s96, |v83|
    s_nop 1
    v_cndmask_b32 v83, v83, v39, vcc
    v_exp_f32 v76, v76
    v_mfma_f32_4x4x4_16b_bf16 v[116:119], v[122:123], v[22:23], 0
    v_exp_f32 v77, v77
    s_waitcnt lgkmcnt(9)
    buffer_load_dwordx4 v[28:31], v[54:55], s[24:27], 0 idxen offen sc1
    buffer_load_dwordx4 v[44:47], v[54:55], s[40:43], 0 idxen offen sc1
    v_exp_f32 v78, v78
    s_sub_u32 s89, s89, 1
    s_cbranch_scc1 ks_rs0
ks_rb0:
    ds_read_u16 v48, v8 offset:0
    ds_read_u16_d16_hi v64, v8 offset:2
    v_exp_f32 v79, v79
    s_nop 0
    v_pk_add_f32 v[76:77], v[76:77], 1.0 op_sel_hi:[1,0]
    v_pk_add_f32 v[78:79], v[78:79], 1.0 op_sel_hi:[1,0]
    v_rcp_f32 v76, v76
    v_rcp_f32 v77, v77
    v_rcp_f32 v78, v78
    v_rcp_f32 v79, v79
    s_nop 0
    v_pk_fma_f32 v[84:85], v[112:113], v[76:77], v[84:85]
    v_pk_fma_f32 v[86:87], v[114:115], v[78:79], v[86:87]
    s_sub_u32 s90, s90, 1
    s_cbranch_scc1 ks_fs0
ks_fb0:
    v_pk_add_f32 v[80:81], v[80:81], v[72:73]
    v_pk_add_f32 v[82:83], v[82:83], v[74:75]
    v_pk_fma_f32 v[80:81], v[64:65], v[2:3], v[80:81] op_sel:[1,0,0] op_sel_hi:[1,1,1]
    v_pk_fma_f32 v[82:83], v[64:65], v[4:5], v[82:83] op_sel:[1,0,0] op_sel_hi:[1,1,1]
    s_waitcnt vmcnt(2)
    v_mfma_f32_4x4x4_16b_f16 v[76:79], v[120:121], v[24:25], 0
    s_mov_b32 s96, 0x41800000
    s_nop 3
    v_cmp_le_f32 vcc, s96, |v76|
    s_nop 1
    v_cndmask_b32 v76, v76, v40, vcc
    v_cmp_le_f32 vcc, s96, |v77|
    s_nop 1
    v_cndmask_b32 v77, v77, v41, vcc
    v_cmp_le_f32 vcc, s96, |v78|
    s_nop 1
    v_cndmask_b32 v78, v78, v42, vcc
    v_cmp_le_f32 vcc, s96, |v79|
    s_nop 1
    v_cndmask_b32 v79, v79, v43, vcc
    v_exp_f32 v80, v80
    v_mfma_f32_4x4x4_16b_bf16 v[112:115], v[122:123], v[26:27], 0
    v_exp_f32 v81, v81
    s_waitcnt lgkmcnt(9)
    buffer_load_dwordx4 v[32:35], v[56:57], s[24:27], 0 idxen offen sc1
    buffer_load_dwordx4 v[16:19], v[56:57], s[40:43], 0 idxen offen sc1
    v_exp_f32 v82, v82
    s_sub_u32 s89, s89, 1
    s_cbranch_scc1 ks_rs1
ks_rb1:
    ds_read_u16 v50, v8 offset:4
    ds_read_u16_d16_hi v65, v8 offset:6
    v_exp_f32 v83, v83
    s_nop 0
    v_pk_add_f32 v[80:81], v[80:81], 1.0 op_sel_hi:[1,0]
    v_pk_add_f32 v[82:83], v[82:83], 1.0 op_sel_hi:[1,0]
    v_rcp_f32 v80, v80
    v_rcp_f32 v81, v81
    v_rcp_f32 v82, v82
    v_rcp_f32 v83, v83
    s_nop 0
    v_pk_fma_f32 v[84:85], v[116:117], v[80:81], v[84:85]
    v_pk_fma_f32 v[86:87], v[118:119], v[82:83], v[86:87]
    s_sub_u32 s90, s90, 1
    s_cbranch_scc1 ks_fs1
ks_fb1:
    v_pk_add_f32 v[76:77], v[76:77], v[72:73]
    v_pk_add_f32 v[78:79], v[78:79], v[74:75]
    v_pk_fma_f32 v[76:77], v[66:67], v[2:3], v[76:77] op_sel:[0,0,0] op_sel_hi:[0,1,1]
    v_pk_fma_f32 v[78:79], v[66:67], v[4:5], v[78:79] op_sel:[0,0,0] op_sel_hi:[0,1,1]
    s_waitcnt vmcnt(2)
    v_mfma_f32_4x4x4_16b_f16 v[80:83], v[120:121], v[28:29], 0
    s_mov_b32 s96, 0x41800000
    s_nop 3
    v_cmp_le_f32 vcc, s96, |v80|
    s_nop 1
    v_cndmask_b32 v80, v80, v44, vcc
    v_cmp_le_f32 vcc, s96, |v81|
    s_nop 1
    v_cndmask_b32 v81, v81, v45, vcc
    v_cmp_le_f32 vcc, s96, |v82|
    s_nop 1
    v_cndmask_b32 v82, v82, v46, vcc
    v_cmp_le_f32 vcc, s96, |v83|
    s_nop 1
    v_cndmask_b32 v83, v83, v47, vcc
    v_exp_f32 v76, v76
    v_mfma_f32_4x4x4_16b_bf16 v[116:119], v[122:123], v[30:31], 0
    v_exp_f32 v77, v77
    s_waitcnt lgkmcnt(9)
    buffer_load_dwordx4 v[36:39], v[58:59], s[24:27], 0 idxen offen sc1
    buffer_load_dwordx4 v[20:23], v[58:59], s[40:43], 0 idxen offen sc1
    v_exp_f32 v78, v78
    s_sub_u32 s89, s89, 1
    s_cbranch_scc1 ks_rs2
ks_rb2:
    ds_read_u16 v52, v8 offset:8
    ds_read_u16_d16_hi v66, v8 offset:10
    v_exp_f32 v79, v79
    s_nop 0
    v_pk_add_f32 v[76:77], v[76:77], 1.0 op_sel_hi:[1,0]
    v_pk_add_f32 v[78:79], v[78:79], 1.0 op_sel_hi:[1,0]
    v_rcp_f32 v76, v76
    v_rcp_f32 v77, v77
    v_rcp_f32 v78, v78
    v_rcp_f32 v79, v79
    s_nop 0
    v_pk_fma_f32 v[84:85], v[112:113], v[76:77], v[84:85]
    v_pk_fma_f32 v[86:87], v[114:115], v[78:79], v[86:87]
    s_sub_u32 s90, s90, 1
    s_cbranch_scc1 ks_fs2
ks_fb2:
    v_pk_add_f32 v[80:81], v[80:81], v[72:73]
    v_pk_add_f32 v[82:83], v[82:83], v[74:75]
    v_pk_fma_f32 v[80:81], v[66:67], v[2:3], v[80:81] op_sel:[1,0,0] op_sel_hi:[1,1,1]
    v_pk_fma_f32 v[82:83], v[66:67], v[4:5], v[82:83] op_sel:[1,0,0] op_sel_hi:[1,1,1]
    s_waitcnt vmcnt(2)
    v_mfma_f32_4x4x4_16b_f16 v[76:79], v[120:121], v[32:33], 0
    s_mov_b32 s96, 0x41800000
    s_nop 3
    v_cmp_le_f32 vcc, s96, |v76|
    s_nop 1
    v_cndmask_b32 v76, v76, v16, vcc
    v_cmp_le_f32 vcc, s96, |v77|
    s_nop 1
    v_cndmask_b32 v77, v77, v17, vcc
    v_cmp_le_f32 vcc, s96, |v78|
    s_nop 1
    v_cndmask_b32 v78, v78, v18, vcc
    v_cmp_le_f32 vcc, s96, |v79|
    s_nop 1
    v_cndmask_b32 v79, v79, v19, vcc
    v_exp_f32 v80, v80
    v_mfma_f32_4x4x4_16b_bf16 v[112:115], v[122:123], v[34:35], 0
    v_exp_f32 v81, v81
    s_waitcnt lgkmcnt(9)
    buffer_load_dwordx4 v[40:43], v[60:61], s[24:27], 0 idxen offen sc1
    buffer_load_dwordx4 v[24:27], v[60:61], s[40:43], 0 idxen offen sc1
    v_exp_f32 v82, v82
    s_sub_u32 s89, s89, 1
    s_cbranch_scc1 ks_rs3
ks_rb3:
    ds_read_u16 v54, v8 offset:12
    ds_read_u16_d16_hi v67, v8 offset:14
    v_exp_f32 v83, v83
    s_nop 0
    v_pk_add_f32 v[80:81], v[80:81], 1.0 op_sel_hi:[1,0]
    v_pk_add_f32 v[82:83], v[82:83], 1.0 op_sel_hi:[1,0]
    v_rcp_f32 v80, v80
    v_rcp_f32 v81, v81
    v_rcp_f32 v82, v82
    v_rcp_f32 v83, v83
    s_nop 0
    v_pk_fma_f32 v[84:85], v[116:117], v[80:81], v[84:85]
    v_pk_fma_f32 v[86:87], v[118:119], v[82:83], v[86:87]
    s_sub_u32 s90, s90, 1
    s_cbranch_scc1 ks_fs3
ks_fb3:
    v_pk_add_f32 v[76:77], v[76:77], v[72:73]
    v_pk_add_f32 v[78:79], v[78:79], v[74:75]
    v_pk_fma_f32 v[76:77], v[68:69], v[2:3], v[76:77] op_sel:[0,0,0] op_sel_hi:[0,1,1]
    v_pk_fma_f32 v[78:79], v[68:69], v[4:5], v[78:79] op_sel:[0,0,0] op_sel_hi:[0,1,1]
    s_waitcnt vmcnt(2)
    v_mfma_f32_4x4x4_16b_f16 v[80:83], v[120:121], v[36:37], 0
    s_mov_b32 s96, 0x41800000
    s_nop 3
    v_cmp_le_f32 vcc, s96, |v80|
    s_nop 1
    v_cndmask_b32 v80, v80, v20, vcc
    v_cmp_le_f32 vcc, s96, |v81|
    s_nop 1
    v_cndmask_b32 v81, v81, v21, vcc
    v_cmp_le_f32 vcc, s96, |v82|
    s_nop 1
    v_cndmask_b32 v82, v82, v22, vcc
    v_cmp_le_f32 vcc, s96, |v83|
    s_nop 1
    v_cndmask_b32 v83, v83, v23, vcc
    v_exp_f32 v76, v76
    v_mfma_f32_4x4x4_16b_bf16 v[116:119], v[122:123], v[38:39], 0
    v_exp_f32 v77, v77
    s_waitcnt lgkmcnt(9)
    buffer_load_dwordx4 v[44:47], v[62:63], s[24:27], 0 idxen offen sc1
    buffer_load_dwordx4 v[28:31], v[62:63], s[40:43], 0 idxen offen sc1
    v_exp_f32 v78, v78
    s_sub_u32 s89, s89, 1
    s_cbranch_scc1 ks_rs4
ks_rb4:
    ds_read_u16 v56, v8 offset:16
    ds_read_u16_d16_hi v68, v8 offset:18
    v_exp_f32 v79, v79
    s_nop 0
    v_pk_add_f32 v[76:77], v[76:77], 1.0 op_sel_hi:[1,0]
    v_pk_add_f32 v[78:79], v[78:79], 1.0 op_sel_hi:[1,0]
    v_rcp_f32 v76, v76
    v_rcp_f32 v77, v77
    v_rcp_f32 v78, v78
    v_rcp_f32 v79, v79
    s_nop 0
    v_pk_fma_f32 v[84:85], v[112:113], v[76:77], v[84:85]
    v_pk_fma_f32 v[86:87], v[114:115], v[78:79], v[86:87]
    s_sub_u32 s90, s90, 1
    s_cbranch_scc1 ks_fs4
ks_fb4:
    v_pk_add_f32 v[80:81], v[80:81], v[72:73]
    v_pk_add_f32 v[82:83], v[82:83], v[74:75]
    v_pk_fma_f32 v[80:81], v[68:69], v[2:3], v[80:81] op_sel:[1,0,0] op_sel_hi:[1,1,1]
    v_pk_fma_f32 v[82:83], v[68:69], v[4:5], v[82:83] op_sel:[1,0,0] op_sel_hi:[1,1,1]
    s_waitcnt vmcnt(2)
    v_mfma_f32_4x4x4_16b_f16 v[76:79], v[120:121], v[40:41], 0
    s_mov_b32 s96, 0x41800000
    s_nop 3
    v_cmp_le_f32 vcc, s96, |v76|
    s_nop 1
    v_cndmask_b32 v76, v76, v24, vcc
    v_cmp_le_f32 vcc, s96, |v77|
    s_nop 1
    v_cndmask_b32 v77, v77, v25, vcc
    v_cmp_le_f32 vcc, s96, |v78|
    s_nop 1
    v_cndmask_b32 v78, v78, v26, vcc
    v_cmp_le_f32 vcc, s96, |v79|
    s_nop 1
    v_cndmask_b32 v79, v79, v27, vcc
    v_exp_f32 v80, v80
    v_mfma_f32_4x4x4_16b_bf16 v[112:115], v[122:123], v[42:43], 0
    v_exp_f32 v81, v81
    s_waitcnt lgkmcnt(9)
    buffer_load_dwordx4 v[16:19], v[48:49], s[24:27], 0 idxen offen sc1
    buffer_load_dwordx4 v[32:35], v[48:49], s[40:43], 0 idxen offen sc1
    v_exp_f32 v82, v82
    s_sub_u32 s89, s89, 1
    s_cbranch_scc1 ks_rs5
ks_rb5:
    ds_read_u16 v58, v8 offset:20
    ds_read_u16_d16_hi v69, v8 offset:22
    v_exp_f32 v83, v83
    s_nop 0
    v_pk_add_f32 v[80:81], v[80:81], 1.0 op_sel_hi:[1,0]
    v_pk_add_f32 v[82:83], v[82:83], 1.0 op_sel_hi:[1,0]
    v_rcp_f32 v80, v80
    v_rcp_f32 v81, v81
    v_rcp_f32 v82, v82
    v_rcp_f32 v83, v83
    s_nop 0
    v_pk_fma_f32 v[84:85], v[116:117], v[80:81], v[84:85]
    v_pk_fma_f32 v[86:87], v[118:119], v[82:83], v[86:87]
    s_sub_u32 s90, s90, 1
    s_cbranch_scc1 ks_fs5
ks_fb5:
    v_pk_add_f32 v[76:77], v[76:77], v[72:73]
    v_pk_add_f32 v[78:79], v[78:79], v[74:75]
    v_pk_fma_f32 v[76:77], v[70:71], v[2:3], v[76:77] op_sel:[0,0,0] op_sel_hi:[0,1,1]
    v_pk_fma_f32 v[78:79], v[70:71], v[4:5], v[78:79] op_sel:[0,0,0] op_sel_hi:[0,1,1]
    s_waitcnt vmcnt(2)
    v_mfma_f32_4x4x4_16b_f16 v[80:83], v[120:121], v[44:45], 0
    s_mov_b32 s96, 0x41800000
    s_nop 3
    v_cmp_le_f32 vcc, s96, |v80|
    s_nop 1
    v_cndmask_b32 v80, v80, v28, vcc
    v_cmp_le_f32 vcc, s96, |v81|
    s_nop 1
    v_cndmask_b32 v81, v81, v29, vcc
    v_cmp_le_f32 vcc, s96, |v82|
    s_nop 1
    v_cndmask_b32 v82, v82, v30, vcc
    v_cmp_le_f32 vcc, s96, |v83|
    s_nop 1
    v_cndmask_b32 v83, v83, v31, vcc
    v_exp_f32 v76, v76
    v_mfma_f32_4x4x4_16b_bf16 v[116:119], v[122:123], v[46:47], 0
    v_exp_f32 v77, v77
    s_waitcnt lgkmcnt(9)
    buffer_load_dwordx4 v[20:23], v[50:51], s[24:27], 0 idxen offen sc1
    buffer_load_dwordx4 v[36:39], v[50:51], s[40:43], 0 idxen offen sc1
    v_exp_f32 v78, v78
    s_sub_u32 s89, s89, 1
    s_cbranch_scc1 ks_rs6
ks_rb6:
    ds_read_u16 v60, v8 offset:24
    ds_read_u16_d16_hi v70, v8 offset:26
    v_exp_f32 v79, v79
    s_nop 0
    v_pk_add_f32 v[76:77], v[76:77], 1.0 op_sel_hi:[1,0]
    v_pk_add_f32 v[78:79], v[78:79], 1.0 op_sel_hi:[1,0]
    v_rcp_f32 v76, v76
    v_rcp_f32 v77, v77
    v_rcp_f32 v78, v78
    v_rcp_f32 v79, v79
    s_nop 0
    v_pk_fma_f32 v[84:85], v[112:113], v[76:77], v[84:85]
    v_pk_fma_f32 v[86:87], v[114:115], v[78:79], v[86:87]
    s_sub_u32 s90, s90, 1
    s_cbranch_scc1 ks_fs6
ks_fb6:
    v_pk_add_f32 v[80:81], v[80:81], v[72:73]
    v_pk_add_f32 v[82:83], v[82:83], v[74:75]
    v_pk_fma_f32 v[80:81], v[70:71], v[2:3], v[80:81] op_sel:[1,0,0] op_sel_hi:[1,1,1]
    v_pk_fma_f32 v[82:83], v[70:71], v[4:5], v[82:83] op_sel:[1,0,0] op_sel_hi:[1,1,1]
    s_waitcnt vmcnt(2)
    v_mfma_f32_4x4x4_16b_f16 v[76:79], v[120:121], v[16:17], 0
    s_mov_b32 s96, 0x41800000
    s_nop 3
    v_cmp_le_f32 vcc, s96, |v76|
    s_nop 1
    v_cndmask_b32 v76, v76, v32, vcc
    v_cmp_le_f32 vcc, s96, |v77|
    s_nop 1
    v_cndmask_b32 v77, v77, v33, vcc
    v_cmp_le_f32 vcc, s96, |v78|
    s_nop 1
    v_cndmask_b32 v78, v78, v34, vcc
    v_cmp_le_f32 vcc, s96, |v79|
    s_nop 1
    v_cndmask_b32 v79, v79, v35, vcc
    v_exp_f32 v80, v80
    v_mfma_f32_4x4x4_16b_bf16 v[112:115], v[122:123], v[18:19], 0
    v_exp_f32 v81, v81
    s_waitcnt lgkmcnt(9)
    buffer_load_dwordx4 v[24:27], v[52:53], s[24:27], 0 idxen offen sc1
    buffer_load_dwordx4 v[40:43], v[52:53], s[40:43], 0 idxen offen sc1
    v_exp_f32 v82, v82
    s_sub_u32 s89, s89, 1
    s_cbranch_scc1 ks_rs7
ks_rb7:
    ds_read_u16 v62, v8 offset:28
    ds_read_u16_d16_hi v71, v8 offset:30
    v_exp_f32 v83, v83
    s_nop 0
    v_pk_add_f32 v[80:81], v[80:81], 1.0 op_sel_hi:[1,0]
    v_pk_add_f32 v[82:83], v[82:83], 1.0 op_sel_hi:[1,0]
    v_rcp_f32 v80, v80
    v_rcp_f32 v81, v81
    v_rcp_f32 v82, v82
    v_rcp_f32 v83, v83
    s_nop 0
    v_pk_fma_f32 v[84:85], v[116:117], v[80:81], v[84:85]
    v_pk_fma_f32 v[86:87], v[118:119], v[82:83], v[86:87]
    v_add_u32 v8, 32, v8
    s_sub_u32 s90, s90, 1
    s_cbranch_scc1 ks_fs7
ks_fb7:
    v_pk_add_f32 v[76:77], v[76:77], v[72:73]
    v_pk_add_f32 v[78:79], v[78:79], v[74:75]
    v_pk_fma_f32 v[76:77], v[64:65], v[2:3], v[76:77] op_sel:[0,0,0] op_sel_hi:[0,1,1]
    v_pk_fma_f32 v[78:79], v[64:65], v[4:5], v[78:79] op_sel:[0,0,0] op_sel_hi:[0,1,1]
    s_branch ks_loop
ks_rs0:
    s_movk_i32 s97, 0
    s_call_b64 s[100:101], k_rdswitch
    s_branch ks_rb0
ks_rs1:
    s_movk_i32 s97, 4
    s_call_b64 s[100:101], k_rdswitch
    s_branch ks_rb1
ks_rs2:
    s_movk_i32 s97, 8
    s_call_b64 s[100:101], k_rdswitch
    s_branch ks_rb2
ks_rs3:
    s_movk_i32 s97, 12
    s_call_b64 s[100:101], k_rdswitch
    s_branch ks_rb3
ks_rs4:
    s_movk_i32 s97, 16
    s_call_b64 s[100:101], k_rdswitch
    s_branch ks_rb4
ks_rs5:
    s_movk_i32 s97, 20
    s_call_b64 s[100:101], k_rdswitch
    s_branch ks_rb5
ks_rs6:
    s_movk_i32 s97, 24
    s_call_b64 s[100:101], k_rdswitch
    s_branch ks_rb6
ks_rs7:
    s_movk_i32 s97, 28
    s_call_b64 s[100:101], k_rdswitch
    s_branch ks_rb7
ks_fs0:
    s_call_b64 s[100:101], ks_flush
    s_cbranch_scc1 ks_done
    s_branch ks_fb0
ks_fs1:
    s_call_b64 s[100:101], ks_flush
    s_cbranch_scc1 ks_done
    s_branch ks_fb1
ks_fs2:
    s_call_b64 s[100:101], ks_flush
    s_cbranch_scc1 ks_done
    s_branch ks_fb2
ks_fs3:
    s_call_b64 s[100:101], ks_flush
    s_cbranch_scc1 ks_done
    s_branch ks_fb3
ks_fs4:
    s_call_b64 s[100:101], ks_flush
    s_cbranch_scc1 ks_done
    s_branch ks_fb4
ks_fs5:
    s_call_b64 s[100:101], ks_flush
    s_cbranch_scc1 ks_done
    s_branch ks_fb5
ks_fs6:
    s_call_b64 s[100:101], ks_flush
    s_cbranch_scc1 ks_done
    s_branch ks_fb6
ks_fs7:
    s_call_b64 s[100:101], ks_flush
    s_cbranch_scc1 ks_done
    s_branch ks_fb7
ks_flush:
    s_add_u32 s92, s92, 1
    s_movk_i32 s96, 128
    v_mov_b32 v96, v12
    s_set_gpr_idx_on s92, gpr_idx(SRC0)
    v_mad_u32_u16 v12, v100, s96, v1
    s_set_gpr_idx_off
    ds_read_b128 v[72:75], v12
    v_pk_mov_b32 v[92:93], v[84:85], v[84:85] op_sel:[0,1]
    v_pk_mov_b32 v[94:95], v[86:87], v[86:87] op_sel:[0,1]
    ds_read_b128 v[84:87], v12 offset:28672
    s_cmp_eq_u32 s3, 1
    s_cbranch_scc0 ks_fout
    ds_write_b128 v96, v[92:95] offset:28672
    s_branch ks_fnext
ks_fout:
    v_pk_mul_f32 v[96:97], v[92:93], s[94:95] op_sel_hi:[1,0]
    v_pk_mul_f32 v[98:99], v[94:95], s[94:95] op_sel_hi:[1,0]
    v_exp_f32 v96, v96
    v_exp_f32 v97, v97
    v_exp_f32 v98, v98
    v_exp_f32 v99, v99
    s_nop 0
    v_pk_add_f32 v[96:97], v[96:97], 1.0 op_sel_hi:[1,0]
    v_pk_add_f32 v[98:99], v[98:99], 1.0 op_sel_hi:[1,0]
    v_rcp_f32 v96, v96
    v_rcp_f32 v97, v97
    v_rcp_f32 v98, v98
    v_rcp_f32 v99, v99
    s_nop 0
    v_pk_mul_f32 v[96:97], v[96:97], v[92:93]
    v_pk_mul_f32 v[98:99], v[98:99], v[94:95]
    v_cvt_pk_bf16_f32 v96, v96, v97
    v_cvt_pk_bf16_f32 v97, v98, v99
    buffer_store_dwordx2 v[96:97], v105, s[48:51], 0 offen nt
ks_fnext:
    v_add_u32 v105, v12, v10
    s_lshr_b32 s88, s88, 8
    s_sub_u32 s90, s88, 1
    s_waitcnt lgkmcnt(0)
    s_setpc_b64 s[100:101]
ks_done:
    s_cmp_eq_u32 s3, 1
    s_cbranch_scc0 k_fin
    s_cmp_lg_u32 s93, 0
    s_cbranch_scc1 k_slow_round
    s_add_u32 s85, s85, 4096
    s_cmp_lt_u32 s85, 800000
    s_cbranch_scc1 k_slow_batch
    s_mov_b32 s3, 2
    s_branch k_slow_round
k_slow:
    s_mov_b32 s3, 1
    s_mov_b32 s85, 0
k_slow_batch:
    s_mov_b64 s[52:53], -1
    s_mov_b64 s[54:55], -1
    s_mov_b64 s[56:57], -1
    s_mov_b64 s[58:59], -1
k_slow_round:
    s_waitcnt vmcnt(0) lgkmcnt(0)
    s_barrier
    s_mov_b32 s28, s10
    s_mov_b32 s29, s11
    s_mov_b32 s30, 3200000
    s_mov_b32 s31, 0x20000
    s_mov_b32 s32, s8
    s_mov_b32 s33, s9
    s_mov_b32 s34, 3200000
    s_mov_b32 s35, 0x20000
    s_mov_b32 s36, s6
    s_mov_b32 s37, s7
    s_mov_b32 s38, 1600000
    s_mov_b32 s39, 0x20000
    v_lshlrev_b32 v61, 4, v0
    v_lshlrev_b32 v62, 3, v0
    s_lshl_b32 s86, s85, 2
    s_lshl_b32 s87, s85, 1
    buffer_load_dwordx4 v[16:19], v61, s[28:31], s86 offen
    buffer_load_dwordx4 v[20:23], v61, s[32:35], s86 offen
    buffer_load_dwordx2 v[24:25], v62, s[36:39], s87 offen
    v_mov_b32 v32, 0xffff
    v_mov_b32 v33, v32
    v_mov_b32 v34, v32
    v_mov_b32 v35, v32
    v_add_u32 v36, 96256, v61
    ds_write_b128 v36, v[32:35] offset:0
    ds_write_b128 v36, v[32:35] offset:16384
    ds_write_b128 v36, v[32:35] offset:32768
    ds_write_b128 v36, v[32:35] offset:42016
    s_mov_b64 exec, -1
    s_movk_i32 s88, 292
    v_mov_b32 v69, 96256
    v_mad_u32_u24 v68, v0, s88, v69
    v_lshlrev_b32 v67, 2, v0
    v_cmp_gt_u32 vcc, 256, v0
    s_nop 1
    v_cndmask_b32 v68, 0, v68, vcc
    v_cmpx_gt_u32 vcc, 320, v0
    ds_write_b32 v67, v68
    s_mov_b64 exec, -1
    ds_write_b32 v11, v11 offset:2316
    v_lshl_add_u32 v63, v0, 2, s85
    v_cmp_gt_u32 vcc, 800000, v63
    s_mov_b64 s[60:61], vcc
    v_mov_b32 v70, 4
    s_movk_i32 s89, 196
    s_mov_b32 s90, 0xffff0000
    s_waitcnt vmcnt(0) lgkmcnt(0)
    s_barrier
    v_subrev_u32 v16, s22, v16
    v_cmp_gt_u32 vcc, s89, v16
    s_and_b64 vcc, vcc, s[60:61]
    s_and_b64 s[52:53], s[52:53], vcc
    s_mov_b64 exec, s[52:53]
    v_lshl_or_b32 v20, v24, 16, v20
    v_lshlrev_b32 v72, 2, v16
    ds_add_rtn_u32 v73, v72, v70 offset:0
    v_mad_u32_u24 v72, v16, s88, v69
    s_waitcnt lgkmcnt(0)
    v_sub_u32 v72, v73, v72
    v_cmpx_gt_u32 vcc, 288, v72
    ds_write_b32 v73, v20
    s_andn2_b64 s[52:53], s[52:53], vcc
    s_mov_b64 exec, s[52:53]
    ds_write_b32 v11, v70 offset:2316
    s_mov_b64 exec, -1
    v_subrev_u32 v17, s22, v17
    v_cmp_gt_u32 vcc, s89, v17
    s_and_b64 vcc, vcc, s[60:61]
    s_and_b64 s[54:55], s[54:55], vcc
    s_mov_b64 exec, s[54:55]
    v_and_or_b32 v21, v24, s90, v21
    v_lshlrev_b32 v72, 2, v17
    ds_add_rtn_u32 v73, v72, v70 offset:0
    v_mad_u32_u24 v72, v17, s88, v69
    s_waitcnt lgkmcnt(0)
    v_sub_u32 v72, v73, v72
    v_cmpx_gt_u32 vcc, 288, v72
    ds_write_b32 v73, v21
    s_andn2_b64 s[54:55], s[54:55], vcc
    s_mov_b64 exec, s[54:55]
    ds_write_b32 v11, v70 offset:2316
    s_mov_b64 exec, -1
    v_subrev_u32 v18, s22, v18
    v_cmp_gt_u32 vcc, s89, v18
    s_and_b64 vcc, vcc, s[60:61]
    s_and_b64 s[56:57], s[56:57], vcc
    s_mov_b64 exec, s[56:57]
    v_lshl_or_b32 v22, v25, 16, v22
    v_lshlrev_b32 v72, 2, v18
    ds_add_rtn_u32 v73, v72, v70 offset:0
    v_mad_u32_u24 v72, v18, s88, v69
    s_waitcnt lgkmcnt(0)
    v_sub_u32 v72, v73, v72
    v_cmpx_gt_u32 vcc, 288, v72
    ds_write_b32 v73, v22
    s_andn2_b64 s[56:57], s[56:57], vcc
    s_mov_b64 exec, s[56:57]
    ds_write_b32 v11, v70 offset:2316
    s_mov_b64 exec, -1
    v_subrev_u32 v19, s22, v19
    v_cmp_gt_u32 vcc, s89, v19
    s_and_b64 vcc, vcc, s[60:61]
    s_and_b64 s[58:59], s[58:59], vcc
    s_mov_b64 exec, s[58:59]
    v_and_or_b32 v23, v25, s90, v23
    v_lshlrev_b32 v72, 2, v19
    ds_add_rtn_u32 v73, v72, v70 offset:0
    v_mad_u32_u24 v72, v19, s88, v69
    s_waitcnt lgkmcnt(0)
    v_sub_u32 v72, v73, v72
    v_cmpx_gt_u32 vcc, 288, v72
    ds_write_b32 v73, v23
    s_andn2_b64 s[58:59], s[58:59], vcc
    s_mov_b64 exec, s[58:59]
    ds_write_b32 v11, v70 offset:2316
    s_mov_b64 exec, -1
    s_waitcnt lgkmcnt(0)
    s_barrier
    s_branch k_presort
k_wide:
    s_mul_i32 s96, s84, 0x9e3779b1
    s_lshr_b32 s96, s96, 28
    s_mul_i32 s96, s96, 0xd00000
    s_sub_u32 s96, 0xe000000, s96
    s_add_u32 s40, s32, s96
    s_addc_u32 s41, s33, 0
    s_mov_b32 s42, s34
    s_mov_b32 s43, 0x20000
    v_and_b32 v66, 31, v0
    v_lshlrev_b32 v66, 7, v66
    v_lshl_add_u32 v66, v117, 4, v66
    v_add_u32 v66, s86, v66
    v_mul_f32 v100, s94, v100
    v_mul_f32 v101, s94, v101
    v_mul_f32 v102, s94, v102
    v_mul_f32 v103, s94, v103
    v_mul_f32 v104, s94, v104
    v_mul_f32 v105, s94, v105
    v_mul_f32 v106, s94, v106
    v_mul_f32 v107, s94, v107
    v_mul_f32 v108, s94, v108
    v_mul_f32 v109, s94, v109
    v_mul_f32 v110, s94, v110
    v_mul_f32 v111, s94, v111
    v_mul_f32 v112, s94, v112
    v_mul_f32 v113, s94, v113
    v_mul_f32 v114, s94, v114
    v_mul_f32 v115, s94, v115
    buffer_store_dwordx4 v[100:103], v66, s[40:43], 0 offen offset:0 sc1
    buffer_store_dwordx4 v[104:107], v66, s[40:43], 0 offen offset:32 sc1
    buffer_store_dwordx4 v[108:111], v66, s[40:43], 0 offen offset:64 sc1
    buffer_store_dwordx4 v[112:115], v66, s[40:43], 0 offen offset:96 sc1
    ds_write_b32 v11, v127 offset:2376
    s_branch k_wide_done
k_fin:
k_end:
    s_endpgm
.section .rodata,"a"
.p2align 6
.amdhsa_kernel gather_scatter__edge_featured_mpnn_egc__graph_kernel
  .amdhsa_next_free_vgpr 128
  .amdhsa_next_free_sgpr 102
  .amdhsa_accum_offset 128
  .amdhsa_group_segment_fixed_size 0
  .amdhsa_kernarg_size 80
  .amdhsa_user_sgpr_count 2
  .amdhsa_user_sgpr_kernarg_segment_ptr 1
  .amdhsa_system_sgpr_workgroup_id_x 1
  .amdhsa_fp16_overflow 1
.end_amdhsa_kernel
```
